```python
import torch

def _softmax(x, axis=-1):
    return torch.softmax(x, dim=axis)
def _gelu(x):
    return torch.nn.functional.gelu(x, approximate="tanh")
def _silu(x):
    return torch.nn.functional.silu(x)
def _sigmoid(x):
    return torch.sigmoid(x)
def _layernorm(x, axis=-1, eps=1e-5):
    m = x.mean(dim=axis, keepdim=True)
    v = x.var(dim=axis, keepdim=True, unbiased=False)
    return (x - m) / torch.sqrt(v + eps)
def _scatter_add(tgt, idx, src, axis=0):
    return tgt.clone().index_add_(axis, idx, src)
def _segment_sum(src, seg, n):
    out = torch.zeros((n,) + src.shape[1:], dtype=src.dtype)
    return out.index_add_(0, seg, src)
def _pad(x, pw):
    flat = tuple(v for pair in reversed(pw) for v in pair)
    return torch.nn.functional.pad(x, flat)

kernel_name = 'standalone__global_local_windowed_global_tokens__prompt'

def setup_inputs():

    _w = (lambda a: (lambda t: t.to(torch.bfloat16) if t.is_floating_point() else t)(torch.as_tensor(a)))
    B, H, S, D = 1, 32, 2048, 128
    return {
        "q": _w((lambda *s: torch.randn(*s, dtype=torch.bfloat16) * 0.8)(B, H, S, D)),
        "k": _w((lambda *s: torch.randn(*s, dtype=torch.bfloat16) * 0.8)(B, H, S, D)),
        "v": _w((lambda *s: torch.randn(*s, dtype=torch.bfloat16) * 0.05)(B, H, S, D)),
        "window": 32,
        "n_global": 2,
    }

def reference(q, k, v, window, n_global):
    B, H, S, D = q.shape
    scale = D ** -0.5
    scores = torch.einsum("bhqd,bhkd->bhqk", q, k) * scale
    idx = torch.arange(S)
    dist = idx[:, None] - idx[None, :]
    local = (dist <= window) & (dist >= -window)
    is_global_q = (idx < n_global)[:, None]
    is_global_k = (idx < n_global)[None, :]
    mask = local | is_global_q | is_global_k
    scores = torch.where(mask[None, None], scores, -1e9)
    p = _softmax(scores, axis=-1)
    return torch.einsum("bhqk,bhkd->bhqd", p, v)
```

```asm
; @launch grid=(256,1,1) block=(704,1,1) lds=163840
.amdgcn_target "amdgcn-amd-amdhsa--gfx950"
.text
.globl standalone__global_local_windowed_global_tokens__prompt_kernel
.p2align 8
.type standalone__global_local_windowed_global_tokens__prompt_kernel,@function
standalone__global_local_windowed_global_tokens__prompt_kernel:
    s_load_dwordx4 s[4:7], s[0:1], 0
    s_load_dwordx2 s[8:9], s[0:1], 16
    s_cmp_ge_u32 s2, 256
    s_cbranch_scc1 L_end
    v_readfirstlane_b32 s44, v0
    v_and_b32 v13, 15, v0
    v_bfe_u32 v14, v0, 4, 2
    s_cmp_eq_u32 s44, 64
    s_cbranch_scc0 L_nocp
    s_getpc_b64 s[18:19]
L_pc:
    v_lshl_add_u32 v158, v14, 4, v13
    v_lshlrev_b32 v158, 7, v158
    s_sub_u32 s18, s18, L_pc-standalone__global_local_windowed_global_tokens__prompt_kernel
    s_subb_u32 s19, s19, 0
    v_add_u32 v159, 0x2000, v158
    v_min_u32 v159, L_codeend-standalone__global_local_windowed_global_tokens__prompt_kernel-4, v159
    global_load_dword v160, v158, s[18:19]
    global_load_dword v161, v159, s[18:19]
L_nocp:
    s_and_b32 s47, s2, 7
    s_lshr_b32 s48, s2, 6
    s_lshl2_add_u32 s53, s47, s48
    s_bfe_u32 s54, s2, 0x30003
    s_lshl_b32 s45, s53, 19
    s_lshl_b32 s47, s54, 16
    s_add_u32 s46, s45, s47
    s_add_u32 s86, s45, 520192
    s_and_b32 s55, s54, 1
    v_lshlrev_b32 v15, 2, v14
    v_mov_b32 v16, 10240
    s_mov_b32 s26, 16777216
    s_mov_b32 s27, 0x20000
    s_lshr_b32 s44, s44, 6
    s_cbranch_scc1 L_notloader
    v_lshlrev_b32 v0, 8, v14
    v_xor_b32 v6, v15, v13
    v_lshl_add_u32 v6, v6, 4, v0
    v_xor_b32 v2, v14, v13
    v_lshl_add_u32 v2, v2, 4, v0
    s_mov_b32 s30, 16777216
    s_mov_b32 s31, 0x20000
    v_mov_b32 v8, 0
    v_mov_b32 v9, 0
    s_mov_b32 m0, 8192
    s_waitcnt lgkmcnt(0)
    s_mov_b64 s[24:25], s[6:7]
    s_mov_b64 s[28:29], s[8:9]
    buffer_load_dwordx4 v2, s[24:27], s45 offen lds
    s_mov_b32 m0, 9216
    s_nop 0
    buffer_load_dwordx4 v6, s[28:31], s45 offen lds
    ds_write_b64 v16, v[8:9]
    s_cmp_eq_u32 s55, 1
    s_cselect_b32 s47, 76032, 0
    s_cselect_b32 s48, 73728, 0
    s_add_u32 s48, s48, s46
    s_sub_u32 s48, s48, 8192
    s_max_i32 s49, s48, s45
    s_min_i32 s49, s49, s86
    s_add_u32 m0, s47, 79360
    s_add_u32 s48, s48, 4096
    buffer_load_dwordx4 v6, s[28:31], s49 offen offset:0 lds
    s_add_u32 m0, s47, 79392
    s_nop 0
    buffer_load_dwordx4 v6, s[28:31], s49 offen offset:1024 lds
    s_add_u32 m0, s47, 79424
    s_nop 0
    buffer_load_dwordx4 v6, s[28:31], s49 offen offset:2048 lds
    s_add_u32 m0, s47, 79456
    s_nop 0
    buffer_load_dwordx4 v6, s[28:31], s49 offen offset:3072 lds
    s_max_i32 s49, s48, s45
    s_min_i32 s49, s49, s86
    s_add_u32 m0, s47, 83584
    s_nop 0
    buffer_load_dwordx4 v6, s[28:31], s49 offen offset:0 lds
    s_add_u32 m0, s47, 83616
    s_nop 0
    buffer_load_dwordx4 v6, s[28:31], s49 offen offset:1024 lds
    s_add_u32 m0, s47, 83648
    s_nop 0
    buffer_load_dwordx4 v6, s[28:31], s49 offen offset:2048 lds
    s_add_u32 m0, s47, 83680
    s_nop 0
    buffer_load_dwordx4 v6, s[28:31], s49 offen offset:3072 lds
    v_xor_b32 v3, 64, v2
    v_xor_b32 v4, 128, v2
    v_xor_b32 v5, 192, v2
    s_waitcnt lgkmcnt(0)
    s_barrier
    s_mul_i32 s83, s55, 61440
    s_mul_i32 s88, s55, -8192
    s_add_u32 s88, s88, 4096
    s_mul_i32 s89, s55, 63360
    s_add_u32 s89, s89, 87808
    s_mul_i32 s90, s55, -8448
    s_add_u32 s90, s90, 4224
    s_add_u32 s80, s83, s46
    s_add_u32 s48, s83, s46
    s_add_u32 m0, s83, 13824
    s_add_u32 s83, s83, s88
    buffer_load_dwordx4 v2, s[24:27], s48 offen offset:0 lds
    buffer_load_dwordx4 v3, s[24:27], s48 offen offset:1024 lds
    buffer_load_dwordx4 v4, s[24:27], s48 offen offset:2048 lds
    buffer_load_dwordx4 v5, s[24:27], s48 offen offset:3072 lds
    s_add_u32 s48, s83, s46
    s_add_u32 m0, s83, 13824
    s_add_u32 s83, s83, s88
    buffer_load_dwordx4 v2, s[24:27], s48 offen offset:0 lds
    buffer_load_dwordx4 v3, s[24:27], s48 offen offset:1024 lds
    buffer_load_dwordx4 v4, s[24:27], s48 offen offset:2048 lds
    buffer_load_dwordx4 v5, s[24:27], s48 offen offset:3072 lds
    s_load_dwordx4 s[12:15], s[0:1], 40
    s_load_dwordx2 s[16:17], s[0:1], 56
    s_mov_b32 s34, 16777216
    s_mov_b32 s35, 0x20000
    s_mov_b32 s38, 256
    s_mov_b32 s39, 0x20000
    s_mov_b32 s42, 16777216
    s_mov_b32 s43, 0x20000
    v_lshrrev_b32 v18, 2, v13
    v_add_u32 v27, v15, v18
    v_and_b32 v19, 3, v13
    v_lshlrev_b32 v25, 4, v19
    v_lshl_add_u32 v25, v27, 8, v25
    v_bfe_u32 v24, v27, 1, 2
    v_xor_b32 v24, v24, v19
    v_lshlrev_b32 v24, 4, v24
    v_lshl_add_u32 v24, v27, 6, v24
    s_mov_b32 s84, -1
    s_nop 0
L_ldloop:
    s_cmp_eq_u32 s84, 9
    s_cbranch_scc1 L_ldhalo
    s_add_u32 s48, s83, s46
    s_add_u32 m0, s83, 13824
    s_add_u32 s83, s83, s88
    buffer_load_dwordx4 v2, s[24:27], s48 offen offset:0 nt lds
    buffer_load_dwordx4 v3, s[24:27], s48 offen offset:1024 nt lds
    buffer_load_dwordx4 v4, s[24:27], s48 offen offset:2048 nt lds
    buffer_load_dwordx4 v5, s[24:27], s48 offen offset:3072 nt lds
    s_add_u32 m0, s89, 0
    s_nop 0
    buffer_load_dwordx4 v6, s[28:31], s80 offen offset:0 nt lds
    s_add_u32 m0, s89, 32
    s_nop 0
    buffer_load_dwordx4 v6, s[28:31], s80 offen offset:1024 nt lds
    s_add_u32 m0, s89, 64
    s_nop 0
    buffer_load_dwordx4 v6, s[28:31], s80 offen offset:2048 nt lds
    s_add_u32 m0, s89, 96
    s_nop 0
    buffer_load_dwordx4 v6, s[28:31], s80 offen offset:3072 nt lds
    s_add_u32 s89, s89, s90
    s_add_u32 s80, s80, s88
L_ldwait:
    s_add_u32 s84, s84, 1
    v_mov_b32 v8, s84
    s_cmp_lt_i32 s84, 14
    s_waitcnt vmcnt(24)
    ds_write_b32 v16, v8
    s_cbranch_scc1 L_ldloop
    s_add_u32 m0, s89, 0
    s_nop 0
    buffer_load_dwordx4 v6, s[28:31], s80 offen offset:0 nt lds
    s_add_u32 m0, s89, 32
    s_nop 0
    buffer_load_dwordx4 v6, s[28:31], s80 offen offset:1024 nt lds
    s_add_u32 m0, s89, 64
    s_nop 0
    buffer_load_dwordx4 v6, s[28:31], s80 offen offset:2048 nt lds
    s_add_u32 m0, s89, 96
    s_nop 0
    buffer_load_dwordx4 v6, s[28:31], s80 offen offset:3072 nt lds
    s_add_u32 s89, s89, s90
    s_add_u32 s80, s80, s88
    s_add_u32 m0, s89, 0
    s_nop 0
    buffer_load_dwordx4 v6, s[28:31], s80 offen offset:0 nt lds
    s_add_u32 m0, s89, 32
    s_nop 0
    buffer_load_dwordx4 v6, s[28:31], s80 offen offset:1024 nt lds
    s_add_u32 m0, s89, 64
    s_nop 0
    buffer_load_dwordx4 v6, s[28:31], s80 offen offset:2048 nt lds
    s_add_u32 m0, s89, 96
    s_nop 0
    buffer_load_dwordx4 v6, s[28:31], s80 offen offset:3072 nt lds
    s_add_u32 s89, s89, s90
    s_add_u32 s80, s80, s88
    s_waitcnt lgkmcnt(0)
    s_mov_b64 s[32:33], s[12:13]
    s_mov_b64 s[36:37], s[14:15]
    s_mov_b64 s[40:41], s[16:17]
    s_mul_i32 s89, s55, 80256
    s_add_u32 s89, s89, 79360
    s_mul_i32 s83, s55, 61440
    s_add_u32 s50, s83, s46
    s_add_u32 s83, s83, 13824
    s_cmp_eq_u32 s50, s45
    s_cselect_b32 s56, 0xffffff00, -1
    s_mov_b32 s57, -1
    s_mov_b32 s92, 0
    v_mov_b32 v8, 15
    s_waitcnt vmcnt(24)
    ds_write_b32 v16, v8
    v_mov_b32 v8, 16
    s_waitcnt vmcnt(16)
    ds_write_b32 v16, v8
    v_mov_b32 v8, 17
    s_waitcnt vmcnt(8)
    ds_write_b32 v16, v8
    v_mov_b32 v8, 18
    s_waitcnt vmcnt(0)
    ds_write_b32 v16, v8
    s_bitcmp1_b32 s92, 8
    s_cbranch_scc1 L_have1
L_poll1:
    ds_read_b32 v27, v16 offset:4
    s_waitcnt lgkmcnt(0)
    v_readfirstlane_b32 s92, v27
    s_nop 0
    s_bitcmp1_b32 s92, 8
    s_cbranch_scc1 L_have1
    s_sleep 1
    s_branch L_poll1
L_have1:
    v_add_u32 v0, s89, v24
    s_add_u32 s89, s89, s90
    ds_read_b128 v[92:95], v0 offset:0
    ds_read_b128 v[96:99], v0 offset:1024
    ds_read_b128 v[100:103], v0 offset:2048
    ds_read_b128 v[104:107], v0 offset:3072
    s_bitcmp1_b32 s92, 9
    s_cbranch_scc1 L_have2
L_poll2:
    ds_read_b32 v27, v16 offset:4
    s_waitcnt lgkmcnt(0)
    v_readfirstlane_b32 s92, v27
    s_nop 0
    s_bitcmp1_b32 s92, 9
    s_cbranch_scc1 L_have2
    s_sleep 1
    s_branch L_poll2
L_have2:
    v_add_u32 v0, s89, v24
    s_add_u32 s89, s89, s90
    ds_read_b128 v[108:111], v0 offset:0
    ds_read_b128 v[112:115], v0 offset:1024
    ds_read_b128 v[116:119], v0 offset:2048
    ds_read_b128 v[120:123], v0 offset:3072
    s_mov_b32 s49, 33554432
L_poll3:
    ds_read_b32 v27, v16 offset:4
    s_waitcnt lgkmcnt(0)
    v_readfirstlane_b32 s47, v27
    s_nop 0
    s_andn2_b32 s47, s49, s47
    s_cbranch_scc0 L_pdone3
    s_sleep 1
    s_branch L_poll3
L_pdone3:
    s_mov_b64 exec, s[56:57]
    buffer_store_dwordx4 v[92:95], v25, s[32:35], s50 offen offset:0 nt sc1
    buffer_store_dwordx4 v[96:99], v25, s[32:35], s50 offen offset:64 nt sc1
    buffer_store_dwordx4 v[100:103], v25, s[32:35], s50 offen offset:128 nt sc1
    buffer_store_dwordx4 v[104:107], v25, s[32:35], s50 offen offset:192 nt sc1
    s_mov_b64 exec, -1
    s_add_u32 s50, s50, s88
    s_bitcmp1_b32 s92, 10
    s_cbranch_scc1 L_have4
L_poll4:
    ds_read_b32 v27, v16 offset:4
    s_waitcnt lgkmcnt(0)
    v_readfirstlane_b32 s92, v27
    s_nop 0
    s_bitcmp1_b32 s92, 10
    s_cbranch_scc1 L_have4
    s_sleep 1
    s_branch L_poll4
L_have4:
    v_add_u32 v0, s83, v24
    s_add_u32 s83, s83, s88
    ds_read_b128 v[92:95], v0 offset:0
    ds_read_b128 v[96:99], v0 offset:1024
    ds_read_b128 v[100:103], v0 offset:2048
    ds_read_b128 v[104:107], v0 offset:3072
    buffer_store_dwordx4 v[108:111], v25, s[32:35], s50 offen offset:0 nt sc1
    buffer_store_dwordx4 v[112:115], v25, s[32:35], s50 offen offset:64 nt sc1
    buffer_store_dwordx4 v[116:119], v25, s[32:35], s50 offen offset:128 nt sc1
    buffer_store_dwordx4 v[120:123], v25, s[32:35], s50 offen offset:192 nt sc1
    s_add_u32 s50, s50, s88
    s_bitcmp1_b32 s92, 11
    s_cbranch_scc1 L_have5
L_poll5:
    ds_read_b32 v27, v16 offset:4
    s_waitcnt lgkmcnt(0)
    v_readfirstlane_b32 s92, v27
    s_nop 0
    s_bitcmp1_b32 s92, 11
    s_cbranch_scc1 L_have5
    s_sleep 1
    s_branch L_poll5
L_have5:
    v_add_u32 v0, s83, v24
    s_add_u32 s83, s83, s88
    ds_read_b128 v[108:111], v0 offset:0
    ds_read_b128 v[112:115], v0 offset:1024
    ds_read_b128 v[116:119], v0 offset:2048
    ds_read_b128 v[120:123], v0 offset:3072
    s_waitcnt lgkmcnt(7)
    buffer_store_dwordx4 v[92:95], v25, s[32:35], s50 offen offset:0 nt sc1
    s_waitcnt lgkmcnt(6)
    buffer_store_dwordx4 v[96:99], v25, s[32:35], s50 offen offset:64 nt sc1
    s_waitcnt lgkmcnt(5)
    buffer_store_dwordx4 v[100:103], v25, s[32:35], s50 offen offset:128 nt sc1
    s_waitcnt lgkmcnt(4)
    buffer_store_dwordx4 v[104:107], v25, s[32:35], s50 offen offset:192 nt sc1
    s_add_u32 s50, s50, s88
    s_bitcmp1_b32 s92, 12
    s_cbranch_scc1 L_have6
L_poll6:
    ds_read_b32 v27, v16 offset:4
    s_waitcnt lgkmcnt(0)
    v_readfirstlane_b32 s92, v27
    s_nop 0
    s_bitcmp1_b32 s92, 12
    s_cbranch_scc1 L_have6
    s_sleep 1
    s_branch L_poll6
L_have6:
    v_add_u32 v0, s83, v24
    s_add_u32 s83, s83, s88
    ds_read_b128 v[92:95], v0 offset:0
    ds_read_b128 v[96:99], v0 offset:1024
    ds_read_b128 v[100:103], v0 offset:2048
    ds_read_b128 v[104:107], v0 offset:3072
    s_waitcnt lgkmcnt(7)
    buffer_store_dwordx4 v[108:111], v25, s[32:35], s50 offen offset:0 nt sc1
    s_waitcnt lgkmcnt(6)
    buffer_store_dwordx4 v[112:115], v25, s[32:35], s50 offen offset:64 nt sc1
    s_waitcnt lgkmcnt(5)
    buffer_store_dwordx4 v[116:119], v25, s[32:35], s50 offen offset:128 nt sc1
    s_waitcnt lgkmcnt(4)
    buffer_store_dwordx4 v[120:123], v25, s[32:35], s50 offen offset:192 nt sc1
    s_add_u32 s50, s50, s88
    s_bitcmp1_b32 s92, 13
    s_cbranch_scc1 L_have7
L_poll7:
    ds_read_b32 v27, v16 offset:4
    s_waitcnt lgkmcnt(0)
    v_readfirstlane_b32 s92, v27
    s_nop 0
    s_bitcmp1_b32 s92, 13
    s_cbranch_scc1 L_have7
    s_sleep 1
    s_branch L_poll7
L_have7:
    v_add_u32 v0, s83, v24
    s_add_u32 s83, s83, s88
    ds_read_b128 v[108:111], v0 offset:0
    ds_read_b128 v[112:115], v0 offset:1024
    ds_read_b128 v[116:119], v0 offset:2048
    ds_read_b128 v[120:123], v0 offset:3072
    s_waitcnt vmcnt(12)
    s_waitcnt lgkmcnt(7)
    buffer_store_dwordx4 v[92:95], v25, s[32:35], s50 offen offset:0 nt sc1
    s_waitcnt lgkmcnt(6)
    buffer_store_dwordx4 v[96:99], v25, s[32:35], s50 offen offset:64 nt sc1
    s_waitcnt lgkmcnt(5)
    buffer_store_dwordx4 v[100:103], v25, s[32:35], s50 offen offset:128 nt sc1
    s_waitcnt lgkmcnt(4)
    buffer_store_dwordx4 v[104:107], v25, s[32:35], s50 offen offset:192 nt sc1
    s_add_u32 s50, s50, s88
    s_bitcmp1_b32 s92, 14
    s_cbranch_scc1 L_have8
L_poll8:
    ds_read_b32 v27, v16 offset:4
    s_waitcnt lgkmcnt(0)
    v_readfirstlane_b32 s92, v27
    s_nop 0
    s_bitcmp1_b32 s92, 14
    s_cbranch_scc1 L_have8
    s_sleep 1
    s_branch L_poll8
L_have8:
    v_add_u32 v0, s83, v24
    s_add_u32 s83, s83, s88
    ds_read_b128 v[92:95], v0 offset:0
    ds_read_b128 v[96:99], v0 offset:1024
    ds_read_b128 v[100:103], v0 offset:2048
    ds_read_b128 v[104:107], v0 offset:3072
    s_waitcnt vmcnt(12)
    s_waitcnt lgkmcnt(7)
    buffer_store_dwordx4 v[108:111], v25, s[32:35], s50 offen offset:0 nt sc1
    s_waitcnt lgkmcnt(6)
    buffer_store_dwordx4 v[112:115], v25, s[32:35], s50 offen offset:64 nt sc1
    s_waitcnt lgkmcnt(5)
    buffer_store_dwordx4 v[116:119], v25, s[32:35], s50 offen offset:128 nt sc1
    s_waitcnt lgkmcnt(4)
    buffer_store_dwordx4 v[120:123], v25, s[32:35], s50 offen offset:192 nt sc1
    s_add_u32 s50, s50, s88
    s_bitcmp1_b32 s92, 15
    s_cbranch_scc1 L_have9
L_poll9:
    ds_read_b32 v27, v16 offset:4
    s_waitcnt lgkmcnt(0)
    v_readfirstlane_b32 s92, v27
    s_nop 0
    s_bitcmp1_b32 s92, 15
    s_cbranch_scc1 L_have9
    s_sleep 1
    s_branch L_poll9
L_have9:
    v_add_u32 v0, s83, v24
    s_add_u32 s83, s83, s88
    ds_read_b128 v[108:111], v0 offset:0
    ds_read_b128 v[112:115], v0 offset:1024
    ds_read_b128 v[116:119], v0 offset:2048
    ds_read_b128 v[120:123], v0 offset:3072
    s_waitcnt vmcnt(12)
    s_waitcnt lgkmcnt(7)
    buffer_store_dwordx4 v[92:95], v25, s[32:35], s50 offen offset:0 nt sc1
    s_waitcnt lgkmcnt(6)
    buffer_store_dwordx4 v[96:99], v25, s[32:35], s50 offen offset:64 nt sc1
    s_waitcnt lgkmcnt(5)
    buffer_store_dwordx4 v[100:103], v25, s[32:35], s50 offen offset:128 nt sc1
    s_waitcnt lgkmcnt(4)
    buffer_store_dwordx4 v[104:107], v25, s[32:35], s50 offen offset:192 nt sc1
    s_add_u32 s50, s50, s88
    s_waitcnt vmcnt(12)
    s_waitcnt lgkmcnt(3)
    buffer_store_dwordx4 v[108:111], v25, s[32:35], s50 offen offset:0 nt sc1
    s_waitcnt lgkmcnt(2)
    buffer_store_dwordx4 v[112:115], v25, s[32:35], s50 offen offset:64 nt sc1
    s_waitcnt lgkmcnt(1)
    buffer_store_dwordx4 v[116:119], v25, s[32:35], s50 offen offset:128 nt sc1
    s_waitcnt lgkmcnt(0)
    buffer_store_dwordx4 v[120:123], v25, s[32:35], s50 offen offset:192 nt sc1
    s_add_u32 s50, s50, s88
    s_endpgm
L_ldhalo:
    s_cmp_eq_u32 s55, 0
    s_cselect_b32 s47, 76032, 0
    s_cselect_b32 s48, 73728, 0
    s_add_u32 s48, s48, s46
    s_sub_u32 s48, s48, 8192
    s_max_i32 s49, s48, s45
    s_min_i32 s49, s49, s86
    s_add_u32 m0, s47, 79360
    s_add_u32 s48, s48, 4096
    buffer_load_dwordx4 v6, s[28:31], s49 offen offset:0 lds
    s_add_u32 m0, s47, 79392
    s_nop 0
    buffer_load_dwordx4 v6, s[28:31], s49 offen offset:1024 lds
    s_add_u32 m0, s47, 79424
    s_nop 0
    buffer_load_dwordx4 v6, s[28:31], s49 offen offset:2048 lds
    s_add_u32 m0, s47, 79456
    s_nop 0
    buffer_load_dwordx4 v6, s[28:31], s49 offen offset:3072 lds
    s_max_i32 s49, s48, s45
    s_min_i32 s49, s49, s86
    s_add_u32 m0, s47, 83584
    s_nop 0
    buffer_load_dwordx4 v6, s[28:31], s49 offen offset:0 lds
    s_add_u32 m0, s47, 83616
    s_nop 0
    buffer_load_dwordx4 v6, s[28:31], s49 offen offset:1024 lds
    s_add_u32 m0, s47, 83648
    s_nop 0
    buffer_load_dwordx4 v6, s[28:31], s49 offen offset:2048 lds
    s_add_u32 m0, s47, 83680
    s_nop 0
    buffer_load_dwordx4 v6, s[28:31], s49 offen offset:3072 lds
    s_branch L_ldwait
L_notloader:
    s_load_dwordx4 s[12:15], s[0:1], 40
    s_load_dwordx2 s[16:17], s[0:1], 56
    s_mov_b32 s34, 16777216
    s_mov_b32 s35, 0x20000
    s_mov_b32 s38, 256
    s_mov_b32 s39, 0x20000
    s_mov_b32 s42, 16777216
    s_mov_b32 s43, 0x20000
    s_mov_b32 s22, 16777216
    s_mov_b32 s23, 0x20000
    v_lshrrev_b32 v18, 2, v13
    v_add_u32 v27, v15, v18
    v_and_b32 v19, 3, v13
    v_lshlrev_b32 v25, 4, v19
    v_lshl_add_u32 v25, v27, 8, v25
    v_bfe_u32 v24, v27, 1, 2
    v_xor_b32 v24, v24, v19
    v_lshlrev_b32 v24, 4, v24
    v_lshl_add_u32 v24, v27, 6, v24
    s_barrier
    s_waitcnt lgkmcnt(0)
    s_mov_b64 s[32:33], s[12:13]
    s_mov_b64 s[36:37], s[14:15]
    s_mov_b64 s[40:41], s[16:17]
    s_mov_b64 s[24:25], s[6:7]
    s_mov_b64 s[20:21], s[4:5]
    s_mov_b32 s58, 0x3e0293ee
    s_mov_b32 s59, 0x3e0293ee
    s_mov_b32 s51, 0xf149f2ca
    s_cmp_le_u32 s44, 2
    s_cbranch_scc1 L_helper
    s_sub_u32 s85, s44, 3
    s_mul_i32 s49, s55, 15
    s_xor_b32 s80, s85, s49
    s_cmp_gt_u32 s85, 1
    s_cbranch_scc1 L_qa_later
    s_sub_u32 s47, s80, 2
    s_cmp_lt_u32 s47, 12
    s_cbranch_scc1 L_kh10
    s_add_u32 s47, s80, -2
    s_cmp_lt_u32 s47, 16
    s_cbranch_scc1 L_kh10_0
    s_lshl_b32 s47, s47, 12
    s_add_u32 s47, s47, s46
    s_max_i32 s47, s47, s45
    s_min_i32 s47, s47, s86
    buffer_load_dwordx4 v[84:87], v25, s[24:27], s47 offen offset:0
    buffer_load_dwordx4 v[88:91], v25, s[24:27], s47 offen offset:64
    buffer_load_dwordx4 v[92:95], v25, s[24:27], s47 offen offset:128
    buffer_load_dwordx4 v[96:99], v25, s[24:27], s47 offen offset:192
L_kh10_0:
    s_add_u32 s47, s80, -1
    s_cmp_lt_u32 s47, 16
    s_cbranch_scc1 L_kh10_1
    s_lshl_b32 s47, s47, 12
    s_add_u32 s47, s47, s46
    s_max_i32 s47, s47, s45
    s_min_i32 s47, s47, s86
    buffer_load_dwordx4 v[100:103], v25, s[24:27], s47 offen offset:0
    buffer_load_dwordx4 v[104:107], v25, s[24:27], s47 offen offset:64
    buffer_load_dwordx4 v[108:111], v25, s[24:27], s47 offen offset:128
    buffer_load_dwordx4 v[112:115], v25, s[24:27], s47 offen offset:192
L_kh10_1:
    s_add_u32 s47, s80, 1
    s_cmp_lt_u32 s47, 16
    s_cbranch_scc1 L_kh10_3
    s_lshl_b32 s47, s47, 12
    s_add_u32 s47, s47, s46
    s_max_i32 s47, s47, s45
    s_min_i32 s47, s47, s86
    buffer_load_dwordx4 v[132:135], v25, s[24:27], s47 offen offset:0
    buffer_load_dwordx4 v[136:139], v25, s[24:27], s47 offen offset:64
    buffer_load_dwordx4 v[140:143], v25, s[24:27], s47 offen offset:128
    buffer_load_dwordx4 v[144:147], v25, s[24:27], s47 offen offset:192
L_kh10_3:
    s_add_u32 s47, s80, 2
    s_cmp_lt_u32 s47, 16
    s_cbranch_scc1 L_kh10_4
    s_lshl_b32 s47, s47, 12
    s_add_u32 s47, s47, s46
    s_max_i32 s47, s47, s45
    s_min_i32 s47, s47, s86
    buffer_load_dwordx4 v[148:151], v25, s[24:27], s47 offen offset:0
    buffer_load_dwordx4 v[152:155], v25, s[24:27], s47 offen offset:64
    buffer_load_dwordx4 v[156:159], v25, s[24:27], s47 offen offset:128
    buffer_load_dwordx4 v[160:163], v25, s[24:27], s47 offen offset:192
L_kh10_4:
L_kh10:
    s_cmp_gt_u32 s85, 1
    s_cbranch_scc1 L_qa_later
    s_lshl_b32 s48, s80, 12
    s_add_u32 s48, s48, s46
    buffer_load_dwordx4 v[28:31], v25, s[20:23], s48 offen offset:0
    buffer_load_dwordx4 v[32:35], v25, s[20:23], s48 offen offset:64
    buffer_load_dwordx4 v[36:39], v25, s[20:23], s48 offen offset:128
    buffer_load_dwordx4 v[40:43], v25, s[20:23], s48 offen offset:192
L_qa_later:
    s_cmp_lt_u32 s85, 6
    s_cbranch_scc1 L_noprio
    s_setprio 3
L_noprio:
    v_xor_b32 v2, v13, v14
    v_lshlrev_b32 v2, 4, v2
    v_lshl_add_u32 v2, v13, 8, v2
    v_lshrrev_b32 v18, 2, v13
    v_and_b32 v19, 3, v13
    v_mul_u32_u24 v164, 320, v18
    v_lshl_add_u32 v164, v19, 3, v164
    v_mul_u32_u24 v27, 1056, v14
    v_xor_b32 v3, 64, v2
    v_xor_b32 v165, 64, v164
    v_xor_b32 v4, 128, v2
    v_xor_b32 v166, 128, v164
    v_xor_b32 v5, 192, v2
    v_xor_b32 v167, 192, v164
    v_add_u32 v6, v27, v164
    v_add_u32 v7, v27, v165
    v_add_u32 v8, v27, v166
    v_add_u32 v9, v27, v167
    v_mov_b32 v20, 0x3f803f80
    v_mov_b32 v21, 0x3f803f80
    v_mov_b32 v22, 0x3f803f80
    v_mov_b32 v23, 0x3f803f80
    v_xor_b32 v12, v19, v14
    v_lshlrev_b32 v12, 4, v12
    v_lshl_add_u32 v12, v19, 8, v12
    v_add_u32 v12, 8192, v12
    v_add_u32 v164, 9216, v164
    v_add_u32 v165, 9216, v165
    v_add_u32 v166, 9216, v166
    v_add_u32 v167, 9216, v167
    s_lshl_b32 s92, s85, 10
    v_bfe_u32 v18, v13, 1, 2
    v_lshlrev_b32 v27, 6, v13
    v_add_u32 v27, s92, v27
    v_xor_b32 v17, v18, v14
    v_lshl_add_u32 v17, v17, 4, v27
    v_lshrrev_b32 v11, 1, v14
    v_xor_b32 v10, v18, v11
    v_lshl_add_u32 v10, v10, 4, v27
    v_and_b32 v11, 1, v14
    v_lshl_add_u32 v10, v11, 3, v10
    v_xor_b32 v11, 32, v10
    v_add_u32 v24, s92, v24
    v_sub_u32 v18, v15, v13
    v_cmp_le_i32 s[2:3], 0, v18
    v_cmp_ge_i32 s[10:11], 0, v18
    v_cmp_le_i32 s[4:5], -1, v18
    v_cmp_ge_i32 s[12:13], -1, v18
    v_cmp_le_i32 s[6:7], -2, v18
    v_cmp_ge_i32 s[14:15], -2, v18
    v_cmp_le_i32 s[8:9], -3, v18
    v_cmp_ge_i32 s[16:17], -3, v18
    v_cmp_eq_u32 s[18:19], 0, v15
    s_sub_u32 s48, 19, s85
    s_cmp_eq_u32 s55, 0
    s_cselect_b32 s48, s85, s48
    s_mul_i32 s49, s48, 4224
    s_add_u32 s49, s49, 79360
    s_lshl_b32 s48, s48, 12
    s_add_u32 s48, s48, 5632
    s_cmp_lt_u32 s85, 2
    s_cselect_b32 s91, s49, s48
    s_sub_u32 s91, s91, s92
    s_lshl_b32 s92, 15, s85
    s_lshr_b32 s92, s92, 4
    s_lshr_b32 s48, s85, 1
    s_lshl_b32 s48, 0x8000, s48
    s_or_b32 s92, s92, s48
    s_lshl_b32 s48, s85, 8
    s_cmp_lt_u32 s85, 2
    s_cselect_b32 s92, s48, s92
    s_mov_b32 s81, 0
    v_mov_b32 v13, s58
    s_add_u32 s82, s85, 3
    s_add_u32 s95, s85, 5
    s_add_u32 s83, s85, 6
    s_and_b32 s83, s83, 7
    s_add_u32 s83, s83, 8
    s_mul_i32 s49, s55, 15
    s_xor_b32 s93, s83, s49
    s_lshl_b32 s88, s80, 12
    s_add_u32 s88, s88, 5632
    s_mul_i32 s90, s80, 4224
    s_add_u32 s90, s90, 79360
    s_cmp_gt_u32 s85, 1
    s_cbranch_scc0 L_block
    s_sub_u32 s49, s85, 1
L_poll11:
    ds_read_b32 v27, v16
    s_waitcnt lgkmcnt(0)
    v_readfirstlane_b32 s47, v27
    s_nop 0
    s_cmp_ge_i32 s47, s49
    s_cbranch_scc1 L_pdone11
    s_sleep 1
    s_branch L_poll11
L_pdone11:
    s_lshl_b32 s48, s80, 12
    s_add_u32 s48, s48, s46
    buffer_load_dwordx4 v[28:31], v25, s[20:23], s48 offen offset:0
    buffer_load_dwordx4 v[32:35], v25, s[20:23], s48 offen offset:64
    buffer_load_dwordx4 v[36:39], v25, s[20:23], s48 offen offset:128
    buffer_load_dwordx4 v[40:43], v25, s[20:23], s48 offen offset:192
L_block:
    ds_read_b32 v27, v16
    s_lshl_b32 s47, s80, 12
    s_add_u32 s50, s47, s46
    v_mov_b32 v18, s51
    v_add_u32 v2, s88, v2
    v_add_u32 v6, s90, v6
    v_add_u32 v3, s88, v3
    v_add_u32 v7, s90, v7
    v_add_u32 v4, s88, v4
    v_add_u32 v8, s90, v8
    v_add_u32 v5, s88, v5
    v_add_u32 v9, s90, v9
    s_lshl_b32 s52, s54, 8
    s_lshl_b32 s47, s80, 4
    s_add_u32 s52, s52, s47
    s_sub_u32 s52, s52, 34
    v_cndmask_b32_e64 v44, v18, 0, s[2:3]
    v_cndmask_b32_e64 v60, v18, 0, s[10:11]
    v_cndmask_b32_e64 v45, v18, 0, s[4:5]
    v_cndmask_b32_e64 v61, v18, 0, s[12:13]
    v_cndmask_b32_e64 v46, v18, 0, s[6:7]
    v_cndmask_b32_e64 v62, v18, 0, s[14:15]
    v_cndmask_b32_e64 v47, v18, 0, s[8:9]
    v_cndmask_b32_e64 v63, v18, 0, s[16:17]
    v_cndmask_b32_e64 v64, v18, 0, s[18:19]
    v_cndmask_b32_e64 v65, v18, 0, s[18:19]
    v_xor_b32 v72, 64, v12
    v_xor_b32 v76, 128, v12
    v_xor_b32 v80, 192, v12
    s_waitcnt lgkmcnt(0)
    v_readfirstlane_b32 s47, v27
    s_nop 0
    s_cmp_ge_i32 s47, s82
    s_cbranch_scc0 L_wait12
L_back12:
    s_sub_u32 s47, s80, 2
    s_cmp_lt_u32 s47, 12
    ds_read_b128 v[68:71], v12
    ds_read_b128 v[72:75], v72
    ds_read_b128 v[76:79], v76
    ds_read_b128 v[80:83], v80
    ds_read_b128 v[116:119], v2 offset:8192
    ds_read_b128 v[120:123], v3 offset:8192
    ds_read_b128 v[124:127], v4 offset:8192
    ds_read_b128 v[128:131], v5 offset:8192
    s_cbranch_scc0 L_halo
    ds_read_b128 v[84:87], v2 offset:0
    ds_read_b128 v[88:91], v3 offset:0
    ds_read_b128 v[92:95], v4 offset:0
    ds_read_b128 v[96:99], v5 offset:0
    ds_read_b128 v[100:103], v2 offset:4096
    ds_read_b128 v[104:107], v3 offset:4096
    ds_read_b128 v[108:111], v4 offset:4096
    ds_read_b128 v[112:115], v5 offset:4096
    ds_read_b128 v[132:135], v2 offset:12288
    ds_read_b128 v[136:139], v3 offset:12288
    ds_read_b128 v[140:143], v4 offset:12288
    ds_read_b128 v[144:147], v5 offset:12288
    ds_read_b128 v[148:151], v2 offset:16384
    ds_read_b128 v[152:155], v3 offset:16384
    ds_read_b128 v[156:159], v4 offset:16384
    ds_read_b128 v[160:163], v5 offset:16384
L_kdone:
    s_waitcnt vmcnt(0)
    ds_write_b128 v24, v[28:31]
    ds_read_b128 v[28:31], v17
    ds_write_b128 v24, v[32:35]
    ds_read_b128 v[32:35], v17
    ds_write_b128 v24, v[36:39]
    ds_read_b128 v[36:39], v17
    ds_write_b128 v24, v[40:43]
    ds_read_b128 v[40:43], v17
    ds_read_b32 v26, v16
    s_cmp_lt_u32 s52, 1967
    s_waitcnt lgkmcnt(7)
    v_mfma_f32_16x16x32_bf16 v[64:67], v[68:71], v[28:31], v[64:67]
    s_waitcnt lgkmcnt(5)
    v_mfma_f32_16x16x32_bf16 v[64:67], v[72:75], v[32:35], v[64:67]
    s_waitcnt lgkmcnt(3)
    v_mfma_f32_16x16x32_bf16 v[64:67], v[76:79], v[36:39], v[64:67]
    s_waitcnt lgkmcnt(1)
    v_mfma_f32_16x16x32_bf16 v[64:67], v[80:83], v[40:43], v[64:67]
    s_cbranch_scc0 L_edge
    v_mfma_f32_16x16x32_bf16 v[44:47], v[84:87], v[28:31], v[44:47]
    v_mfma_f32_16x16x32_bf16 v[44:47], v[88:91], v[32:35], v[44:47]
    v_mfma_f32_16x16x32_bf16 v[44:47], v[92:95], v[36:39], v[44:47]
    v_mfma_f32_16x16x32_bf16 v[44:47], v[96:99], v[40:43], v[44:47]
    v_mfma_f32_16x16x32_bf16 v[48:51], v[100:103], v[28:31], 0
    v_mfma_f32_16x16x32_bf16 v[48:51], v[104:107], v[32:35], v[48:51]
    s_waitcnt lgkmcnt(0)
    v_readfirstlane_b32 s47, v26
    s_nop 0
    s_cmp_ge_i32 s47, s95
    s_cbranch_scc0 L_wait13
L_back13:
    v_mfma_f32_16x16x32_bf16 v[48:51], v[108:111], v[36:39], v[48:51]
    v_mfma_f32_16x16x32_bf16 v[48:51], v[112:115], v[40:43], v[48:51]
    v_mfma_f32_16x16x32_bf16 v[52:55], v[116:119], v[28:31], 0
    ds_read_b64_tr_b16 v[92:93], v6 offset:0
    ds_read_b64_tr_b16 v[94:95], v6 offset:4224
    v_mfma_f32_16x16x32_bf16 v[52:55], v[120:123], v[32:35], v[52:55]
    ds_read_b64_tr_b16 v[96:97], v6 offset:8448
    ds_read_b64_tr_b16 v[98:99], v6 offset:12672
    v_mfma_f32_16x16x32_bf16 v[52:55], v[124:127], v[36:39], v[52:55]
    ds_read_b64_tr_b16 v[100:101], v6 offset:16896
    ds_read_b64_tr_b16 v[102:103], v164 offset:0
    v_mfma_f32_16x16x32_bf16 v[52:55], v[128:131], v[40:43], v[52:55]
    ds_read_b64_tr_b16 v[104:105], v6 offset:32
    ds_read_b64_tr_b16 v[106:107], v6 offset:4256
    v_mfma_f32_16x16x32_bf16 v[56:59], v[132:135], v[28:31], 0
    ds_read_b64_tr_b16 v[108:109], v6 offset:8480
    ds_read_b64_tr_b16 v[110:111], v6 offset:12704
    v_mfma_f32_16x16x32_bf16 v[56:59], v[136:139], v[32:35], v[56:59]
    ds_read_b64_tr_b16 v[112:113], v6 offset:16928
    ds_read_b64_tr_b16 v[114:115], v164 offset:32
    v_mfma_f32_16x16x32_bf16 v[56:59], v[140:143], v[36:39], v[56:59]
    ds_read_b64_tr_b16 v[116:117], v7 offset:0
    ds_read_b64_tr_b16 v[118:119], v7 offset:4224
    v_mfma_f32_16x16x32_bf16 v[56:59], v[144:147], v[40:43], v[56:59]
    ds_read_b64_tr_b16 v[120:121], v7 offset:8448
    ds_read_b64_tr_b16 v[122:123], v7 offset:12672
    v_mfma_f32_16x16x32_bf16 v[60:63], v[148:151], v[28:31], v[60:63]
    ds_read_b64_tr_b16 v[124:125], v7 offset:16896
    ds_read_b64_tr_b16 v[126:127], v165 offset:0
    v_mfma_f32_16x16x32_bf16 v[60:63], v[152:155], v[32:35], v[60:63]
    ds_read_b64_tr_b16 v[128:129], v7 offset:32
    ds_read_b64_tr_b16 v[130:131], v7 offset:4256
    v_mfma_f32_16x16x32_bf16 v[60:63], v[156:159], v[36:39], v[60:63]
    ds_read_b64_tr_b16 v[132:133], v7 offset:8480
    ds_read_b64_tr_b16 v[134:135], v7 offset:12704
    v_mfma_f32_16x16x32_bf16 v[60:63], v[160:163], v[40:43], v[60:63]
    ds_read_b64_tr_b16 v[136:137], v7 offset:16928
    ds_read_b64_tr_b16 v[138:139], v165 offset:32
    ds_read_b64_tr_b16 v[140:141], v8 offset:0
    ds_read_b64_tr_b16 v[142:143], v8 offset:4224
    ds_read_b64_tr_b16 v[144:145], v8 offset:8448
    ds_read_b64_tr_b16 v[146:147], v8 offset:12672
    ds_read_b64_tr_b16 v[148:149], v8 offset:16896
    ds_read_b64_tr_b16 v[150:151], v166 offset:0
    ds_read_b64_tr_b16 v[152:153], v8 offset:32
    ds_read_b64_tr_b16 v[154:155], v8 offset:4256
    ds_read_b64_tr_b16 v[156:157], v8 offset:8480
    ds_read_b64_tr_b16 v[158:159], v8 offset:12704
    ds_read_b64_tr_b16 v[160:161], v8 offset:16928
    ds_read_b64_tr_b16 v[162:163], v166 offset:32
    v_max3_f32 v18, v64, v65, v44
    v_max3_f32 v18, v18, v45, v46
    v_max3_f32 v18, v18, v47, v48
    v_max3_f32 v18, v18, v49, v50
    v_max3_f32 v18, v18, v51, v52
    v_max3_f32 v18, v18, v53, v54
    v_max3_f32 v18, v18, v55, v56
    v_max3_f32 v18, v18, v57, v58
    v_max3_f32 v18, v18, v59, v60
    v_max3_f32 v18, v18, v61, v62
    v_max_f32 v18, v18, v63
L_join:
    v_mov_b32 v19, v18
    s_cmp_eq_u32 s81, 0
    s_cbranch_scc1 L_first
L_second:
    v_permlane32_swap_b32 v18, v19
    v_max_f32 v18, v18, v19
    v_mov_b32 v19, v18
    s_nop 1
    v_permlane16_swap_b32 v18, v19
    v_max_f32 v18, v18, v19
    v_mul_f32 v18, v13, v18
    v_fma_f32 v44, v44, v13, -v18
    v_fma_f32 v45, v45, v13, -v18
    v_exp_f32 v44, v44
    v_fma_f32 v46, v46, v13, -v18
    v_exp_f32 v45, v45
    v_fma_f32 v47, v47, v13, -v18
    v_exp_f32 v46, v46
    v_fma_f32 v48, v48, v13, -v18
    v_cvt_pk_bf16_f32 v44, v44, v45
    v_exp_f32 v47, v47
    v_fma_f32 v49, v49, v13, -v18
    v_exp_f32 v48, v48
    v_fma_f32 v50, v50, v13, -v18
    v_cvt_pk_bf16_f32 v45, v46, v47
    v_exp_f32 v49, v49
    v_fma_f32 v51, v51, v13, -v18
    v_exp_f32 v50, v50
    v_cvt_pk_bf16_f32 v46, v48, v49
    v_exp_f32 v51, v51
    v_fma_f32 v52, v52, v13, -v18
    v_fma_f32 v53, v53, v13, -v18
    v_cvt_pk_bf16_f32 v47, v50, v51
    v_exp_f32 v52, v52
    v_fma_f32 v54, v54, v13, -v18
    v_exp_f32 v53, v53
    v_fma_f32 v55, v55, v13, -v18
    v_exp_f32 v54, v54
    v_fma_f32 v56, v56, v13, -v18
    v_mfma_f32_16x16x32_bf16 v[88:91], v[20:23], v[44:47], 0
    v_cvt_pk_bf16_f32 v48, v52, v53
    v_exp_f32 v55, v55
    v_fma_f32 v57, v57, v13, -v18
    s_waitcnt lgkmcnt(15)
    v_mfma_f32_16x16x32_bf16 v[68:71], v[92:95], v[44:47], 0
    v_exp_f32 v56, v56
    v_fma_f32 v58, v58, v13, -v18
    v_cvt_pk_bf16_f32 v49, v54, v55
    v_mfma_f32_16x16x32_bf16 v[72:75], v[104:107], v[44:47], 0
    v_exp_f32 v57, v57
    v_fma_f32 v59, v59, v13, -v18
    v_exp_f32 v58, v58
    v_mfma_f32_16x16x32_bf16 v[76:79], v[116:119], v[44:47], 0
    v_cvt_pk_bf16_f32 v50, v56, v57
    v_exp_f32 v59, v59
    v_fma_f32 v60, v60, v13, -v18
    v_mfma_f32_16x16x32_bf16 v[80:83], v[128:131], v[44:47], 0
    v_fma_f32 v61, v61, v13, -v18
    v_cvt_pk_bf16_f32 v51, v58, v59
    s_waitcnt lgkmcnt(10)
    v_mfma_f32_16x16x32_bf16 v[84:87], v[140:143], v[44:47], 0
    v_exp_f32 v60, v60
    v_fma_f32 v62, v62, v13, -v18
    s_waitcnt lgkmcnt(4)
    v_mfma_f32_16x16x32_bf16 v[56:59], v[152:155], v[44:47], 0
    v_exp_f32 v61, v61
    v_fma_f32 v63, v63, v13, -v18
    v_mfma_f32_16x16x32_bf16 v[88:91], v[20:23], v[48:51], v[88:91]
    v_exp_f32 v62, v62
    v_fma_f32 v64, v64, v13, -v18
    v_mfma_f32_16x16x32_bf16 v[68:71], v[96:99], v[48:51], v[68:71]
    v_cvt_pk_bf16_f32 v52, v60, v61
    v_mfma_f32_16x16x32_bf16 v[72:75], v[108:111], v[48:51], v[72:75]
    v_exp_f32 v63, v63
    v_fma_f32 v65, v65, v13, -v18
    v_mfma_f32_16x16x32_bf16 v[76:79], v[120:123], v[48:51], v[76:79]
    v_exp_f32 v64, v64
    v_cvt_pk_bf16_f32 v53, v62, v63
    v_mfma_f32_16x16x32_bf16 v[80:83], v[132:135], v[48:51], v[80:83]
    v_exp_f32 v65, v65
    v_mov_b32 v55, 0
    v_mfma_f32_16x16x32_bf16 v[84:87], v[144:147], v[48:51], v[84:87]
    v_cvt_pk_bf16_f32 v54, v64, v65
    s_waitcnt lgkmcnt(2)
    v_mfma_f32_16x16x32_bf16 v[56:59], v[156:159], v[48:51], v[56:59]
    s_cmp_eq_u32 s81, 0
    s_cbranch_scc1 L_park
    v_mfma_f32_16x16x32_bf16 v[88:91], v[20:23], v[52:55], v[88:91]
    v_mfma_f32_16x16x32_bf16 v[68:71], v[100:103], v[52:55], v[68:71]
    v_mfma_f32_16x16x32_bf16 v[72:75], v[112:115], v[52:55], v[72:75]
    ds_read_b64_tr_b16 v[92:93], v9 offset:0
    v_mfma_f32_16x16x32_bf16 v[76:79], v[124:127], v[52:55], v[76:79]
    ds_read_b64_tr_b16 v[94:95], v9 offset:4224
    ds_read_b64_tr_b16 v[96:97], v9 offset:8448
    v_mfma_f32_16x16x32_bf16 v[80:83], v[136:139], v[52:55], v[80:83]
    ds_read_b64_tr_b16 v[98:99], v9 offset:12672
    ds_read_b64_tr_b16 v[100:101], v9 offset:16896
    v_mfma_f32_16x16x32_bf16 v[84:87], v[148:151], v[52:55], v[84:87]
    ds_read_b64_tr_b16 v[102:103], v167 offset:0
    ds_read_b64_tr_b16 v[104:105], v9 offset:32
    s_waitcnt lgkmcnt(7)
    v_mfma_f32_16x16x32_bf16 v[56:59], v[160:163], v[52:55], v[56:59]
    ds_read_b64_tr_b16 v[106:107], v9 offset:4256
    ds_read_b64_tr_b16 v[108:109], v9 offset:8480
    ds_read_b64_tr_b16 v[110:111], v9 offset:12704
    ds_read_b64_tr_b16 v[112:113], v9 offset:16928
    ds_read_b64_tr_b16 v[114:115], v167 offset:32
    v_rcp_f32 v18, v88
    s_nop 0
    v_mul_f32 v68, v68, v18
    v_mul_f32 v69, v69, v18
    v_mul_f32 v70, v70, v18
    v_mul_f32 v71, v71, v18
    s_waitcnt lgkmcnt(10)
    v_mfma_f32_16x16x32_bf16 v[60:63], v[92:95], v[44:47], 0
    v_cvt_pk_bf16_f32 v132, v68, v69
    v_cvt_pk_bf16_f32 v133, v70, v71
    v_mul_f32 v72, v72, v18
    v_mul_f32 v73, v73, v18
    s_waitcnt lgkmcnt(8)
    v_mfma_f32_16x16x32_bf16 v[60:63], v[96:99], v[48:51], v[60:63]
    v_mul_f32 v74, v74, v18
    v_mul_f32 v75, v75, v18
    v_cvt_pk_bf16_f32 v134, v72, v73
    v_cvt_pk_bf16_f32 v135, v74, v75
    s_waitcnt lgkmcnt(6)
    v_mfma_f32_16x16x32_bf16 v[60:63], v[100:103], v[52:55], v[60:63]
    v_mul_f32 v76, v76, v18
    v_mul_f32 v77, v77, v18
    v_mul_f32 v78, v78, v18
    v_mul_f32 v79, v79, v18
    s_waitcnt lgkmcnt(4)
    v_mfma_f32_16x16x32_bf16 v[64:67], v[104:107], v[44:47], 0
    v_cvt_pk_bf16_f32 v136, v76, v77
    v_cvt_pk_bf16_f32 v137, v78, v79
    v_mul_f32 v80, v80, v18
    v_mul_f32 v81, v81, v18
    s_waitcnt lgkmcnt(2)
    v_mfma_f32_16x16x32_bf16 v[64:67], v[108:111], v[48:51], v[64:67]
    v_mul_f32 v82, v82, v18
    v_mul_f32 v83, v83, v18
    v_cvt_pk_bf16_f32 v138, v80, v81
    v_cvt_pk_bf16_f32 v139, v82, v83
    s_waitcnt lgkmcnt(0)
    v_mfma_f32_16x16x32_bf16 v[64:67], v[112:115], v[52:55], v[64:67]
    ds_write_b64 v10, v[132:133]
    ds_write_b64 v11, v[134:135]
    ds_read_b128 v[116:119], v24
    ds_write_b64 v10, v[136:137]
    ds_write_b64 v11, v[138:139]
    ds_read_b128 v[120:123], v24
    v_mul_f32 v84, v84, v18
    v_mul_f32 v85, v85, v18
    v_mul_f32 v86, v86, v18
    v_mul_f32 v87, v87, v18
    v_cvt_pk_bf16_f32 v140, v84, v85
    v_cvt_pk_bf16_f32 v141, v86, v87
    v_mul_f32 v56, v56, v18
    v_mul_f32 v57, v57, v18
    v_mul_f32 v58, v58, v18
    v_mul_f32 v59, v59, v18
    v_cvt_pk_bf16_f32 v142, v56, v57
    v_cvt_pk_bf16_f32 v143, v58, v59
    v_mul_f32 v60, v60, v18
    v_mul_f32 v61, v61, v18
    v_mul_f32 v62, v62, v18
    v_mul_f32 v63, v63, v18
    v_cvt_pk_bf16_f32 v144, v60, v61
    v_cvt_pk_bf16_f32 v145, v62, v63
    v_mul_f32 v64, v64, v18
    v_mul_f32 v65, v65, v18
    v_mul_f32 v66, v66, v18
    v_mul_f32 v67, v67, v18
    v_cvt_pk_bf16_f32 v146, v64, v65
    v_cvt_pk_bf16_f32 v147, v66, v67
    ds_write_b64 v10, v[140:141]
    ds_write_b64 v11, v[142:143]
    ds_read_b128 v[124:127], v24
    ds_write_b64 v10, v[144:145]
    ds_write_b64 v11, v[146:147]
    ds_read_b128 v[128:131], v24
    s_waitcnt lgkmcnt(9)
    buffer_store_dwordx4 v[116:119], v25, s[32:35], s50 offen offset:0 nt sc1
    s_waitcnt lgkmcnt(6)
    buffer_store_dwordx4 v[120:123], v25, s[32:35], s50 offen offset:64 nt sc1
    s_waitcnt lgkmcnt(3)
    buffer_store_dwordx4 v[124:127], v25, s[32:35], s50 offen offset:128 nt sc1
    s_waitcnt lgkmcnt(0)
    buffer_store_dwordx4 v[128:131], v25, s[32:35], s50 offen offset:192 nt sc1
    s_endpgm
L_park:
    v_add_u32 v0, s91, v10
    v_add_u32 v26, s91, v11
    ds_read_b32 v27, v16 offset:4
    v_mfma_f32_16x16x32_bf16 v[88:91], v[20:23], v[52:55], v[88:91]
    v_mfma_f32_16x16x32_bf16 v[68:71], v[100:103], v[52:55], v[68:71]
    v_mfma_f32_16x16x32_bf16 v[72:75], v[112:115], v[52:55], v[72:75]
    ds_read_b64_tr_b16 v[92:93], v9 offset:0
    v_mfma_f32_16x16x32_bf16 v[76:79], v[124:127], v[52:55], v[76:79]
    ds_read_b64_tr_b16 v[94:95], v9 offset:4224
    ds_read_b64_tr_b16 v[96:97], v9 offset:8448
    v_mfma_f32_16x16x32_bf16 v[80:83], v[136:139], v[52:55], v[80:83]
    ds_read_b64_tr_b16 v[98:99], v9 offset:12672
    ds_read_b64_tr_b16 v[100:101], v9 offset:16896
    v_mfma_f32_16x16x32_bf16 v[84:87], v[148:151], v[52:55], v[84:87]
    ds_read_b64_tr_b16 v[102:103], v167 offset:0
    ds_read_b64_tr_b16 v[104:105], v9 offset:32
    s_waitcnt lgkmcnt(8)
    v_mfma_f32_16x16x32_bf16 v[56:59], v[160:163], v[52:55], v[56:59]
    ds_read_b64_tr_b16 v[106:107], v9 offset:4256
    ds_read_b64_tr_b16 v[108:109], v9 offset:8480
    ds_read_b64_tr_b16 v[110:111], v9 offset:12704
    ds_read_b64_tr_b16 v[112:113], v9 offset:16928
    ds_read_b64_tr_b16 v[114:115], v167 offset:32
    v_rcp_f32 v18, v88
    s_waitcnt lgkmcnt(12)
    v_readfirstlane_b32 s47, v27
    s_nop 0
    s_andn2_b32 s47, s92, s47
    s_cbranch_scc0 L_pdone15
L_poll15:
    ds_read_b32 v27, v16 offset:4
    s_waitcnt lgkmcnt(0)
    v_readfirstlane_b32 s47, v27
    s_nop 0
    s_andn2_b32 s47, s92, s47
    s_cbranch_scc0 L_pdone15
    s_sleep 1
    s_branch L_poll15
L_pdone15:
    v_mul_f32 v68, v68, v18
    v_mul_f32 v69, v69, v18
    v_mul_f32 v70, v70, v18
    v_mul_f32 v71, v71, v18
    s_waitcnt lgkmcnt(10)
    v_mfma_f32_16x16x32_bf16 v[60:63], v[92:95], v[44:47], 0
    v_cvt_pk_bf16_f32 v132, v68, v69
    v_cvt_pk_bf16_f32 v133, v70, v71
    v_mul_f32 v72, v72, v18
    v_mul_f32 v73, v73, v18
    s_waitcnt lgkmcnt(8)
    v_mfma_f32_16x16x32_bf16 v[60:63], v[96:99], v[48:51], v[60:63]
    v_mul_f32 v74, v74, v18
    v_mul_f32 v75, v75, v18
    v_cvt_pk_bf16_f32 v134, v72, v73
    v_cvt_pk_bf16_f32 v135, v74, v75
    s_waitcnt lgkmcnt(6)
    v_mfma_f32_16x16x32_bf16 v[60:63], v[100:103], v[52:55], v[60:63]
    v_mul_f32 v76, v76, v18
    v_mul_f32 v77, v77, v18
    v_mul_f32 v78, v78, v18
    v_mul_f32 v79, v79, v18
    s_waitcnt lgkmcnt(4)
    v_mfma_f32_16x16x32_bf16 v[64:67], v[104:107], v[44:47], 0
    v_cvt_pk_bf16_f32 v136, v76, v77
    v_cvt_pk_bf16_f32 v137, v78, v79
    v_mul_f32 v80, v80, v18
    v_mul_f32 v81, v81, v18
    s_waitcnt lgkmcnt(2)
    v_mfma_f32_16x16x32_bf16 v[64:67], v[108:111], v[48:51], v[64:67]
    v_mul_f32 v82, v82, v18
    v_mul_f32 v83, v83, v18
    v_cvt_pk_bf16_f32 v138, v80, v81
    v_cvt_pk_bf16_f32 v139, v82, v83
    s_waitcnt lgkmcnt(0)
    v_mfma_f32_16x16x32_bf16 v[64:67], v[112:115], v[52:55], v[64:67]
    ds_write_b64 v0, v[132:133] offset:0
    ds_write_b64 v26, v[134:135] offset:0
    ds_write_b64 v0, v[136:137] offset:1024
    ds_write_b64 v26, v[138:139] offset:1024
    v_mul_f32 v84, v84, v18
    v_mul_f32 v85, v85, v18
    v_mul_f32 v86, v86, v18
    v_mul_f32 v87, v87, v18
    v_cvt_pk_bf16_f32 v140, v84, v85
    v_cvt_pk_bf16_f32 v141, v86, v87
    v_mul_f32 v56, v56, v18
    v_mul_f32 v57, v57, v18
    v_mul_f32 v58, v58, v18
    v_mul_f32 v59, v59, v18
    v_cvt_pk_bf16_f32 v142, v56, v57
    v_cvt_pk_bf16_f32 v143, v58, v59
    v_mul_f32 v60, v60, v18
    v_mul_f32 v61, v61, v18
    v_mul_f32 v62, v62, v18
    v_mul_f32 v63, v63, v18
    v_cvt_pk_bf16_f32 v144, v60, v61
    v_cvt_pk_bf16_f32 v145, v62, v63
    v_mul_f32 v64, v64, v18
    v_mul_f32 v65, v65, v18
    v_mul_f32 v66, v66, v18
    v_mul_f32 v67, v67, v18
    v_cvt_pk_bf16_f32 v146, v64, v65
    v_cvt_pk_bf16_f32 v147, v66, v67
    ds_write_b64 v0, v[140:141] offset:2048
    ds_write_b64 v26, v[142:143] offset:2048
    ds_write_b64 v0, v[144:145] offset:3072
    ds_write_b64 v26, v[146:147] offset:3072
    s_add_u32 s48, s85, 8
    s_waitcnt lgkmcnt(0)
    s_lshl_b32 s47, 1, s48
    v_mov_b32 v27, s47
    s_mov_b64 exec, 1
    ds_or_b32 v16, v27 offset:4
    s_mov_b64 exec, -1
    s_sub_u32 s48, s93, s80
    s_lshl_b32 s88, s48, 12
    s_mul_i32 s90, s48, 4224
    s_mov_b32 s80, s93
    s_sub_u32 s47, s80, 2
    s_cmp_lt_u32 s47, 12
    s_cbranch_scc1 L_kh16
    s_add_u32 s47, s80, -2
    s_cmp_lt_u32 s47, 16
    s_cbranch_scc1 L_kh16_0
    s_lshl_b32 s47, s47, 12
    s_add_u32 s47, s47, s46
    s_max_i32 s47, s47, s45
    s_min_i32 s47, s47, s86
    buffer_load_dwordx4 v[84:87], v25, s[24:27], s47 offen offset:0
    buffer_load_dwordx4 v[88:91], v25, s[24:27], s47 offen offset:64
    buffer_load_dwordx4 v[92:95], v25, s[24:27], s47 offen offset:128
    buffer_load_dwordx4 v[96:99], v25, s[24:27], s47 offen offset:192
L_kh16_0:
    s_add_u32 s47, s80, -1
    s_cmp_lt_u32 s47, 16
    s_cbranch_scc1 L_kh16_1
    s_lshl_b32 s47, s47, 12
    s_add_u32 s47, s47, s46
    s_max_i32 s47, s47, s45
    s_min_i32 s47, s47, s86
    buffer_load_dwordx4 v[100:103], v25, s[24:27], s47 offen offset:0
    buffer_load_dwordx4 v[104:107], v25, s[24:27], s47 offen offset:64
    buffer_load_dwordx4 v[108:111], v25, s[24:27], s47 offen offset:128
    buffer_load_dwordx4 v[112:115], v25, s[24:27], s47 offen offset:192
L_kh16_1:
    s_add_u32 s47, s80, 1
    s_cmp_lt_u32 s47, 16
    s_cbranch_scc1 L_kh16_3
    s_lshl_b32 s47, s47, 12
    s_add_u32 s47, s47, s46
    s_max_i32 s47, s47, s45
    s_min_i32 s47, s47, s86
    buffer_load_dwordx4 v[132:135], v25, s[24:27], s47 offen offset:0
    buffer_load_dwordx4 v[136:139], v25, s[24:27], s47 offen offset:64
    buffer_load_dwordx4 v[140:143], v25, s[24:27], s47 offen offset:128
    buffer_load_dwordx4 v[144:147], v25, s[24:27], s47 offen offset:192
L_kh16_3:
    s_add_u32 s47, s80, 2
    s_cmp_lt_u32 s47, 16
    s_cbranch_scc1 L_kh16_4
    s_lshl_b32 s47, s47, 12
    s_add_u32 s47, s47, s46
    s_max_i32 s47, s47, s45
    s_min_i32 s47, s47, s86
    buffer_load_dwordx4 v[148:151], v25, s[24:27], s47 offen offset:0
    buffer_load_dwordx4 v[152:155], v25, s[24:27], s47 offen offset:64
    buffer_load_dwordx4 v[156:159], v25, s[24:27], s47 offen offset:128
    buffer_load_dwordx4 v[160:163], v25, s[24:27], s47 offen offset:192
L_kh16_4:
L_kh16:
    s_add_u32 s82, s83, 2
    s_min_u32 s82, s82, 15
    s_cmp_gt_u32 s82, 11
    s_addc_u32 s82, s82, 1
    s_add_u32 s95, s83, 4
    s_min_u32 s95, s95, 16
    s_cmp_gt_u32 s95, 11
    s_addc_u32 s95, s95, 1
    s_mov_b32 s81, 1
    s_cmp_ge_u32 s85, 6
    s_cbranch_scc1 L_block
    s_sub_u32 s49, s82, 3
    s_max_u32 s49, s49, 15
L_poll17:
    ds_read_b32 v27, v16
    s_waitcnt lgkmcnt(0)
    v_readfirstlane_b32 s47, v27
    s_nop 0
    s_cmp_ge_i32 s47, s49
    s_cbranch_scc1 L_pdone17
    s_sleep 1
    s_branch L_poll17
L_pdone17:
    s_lshl_b32 s48, s80, 12
    s_add_u32 s48, s48, s46
    buffer_load_dwordx4 v[28:31], v25, s[20:23], s48 offen offset:0
    buffer_load_dwordx4 v[32:35], v25, s[20:23], s48 offen offset:64
    buffer_load_dwordx4 v[36:39], v25, s[20:23], s48 offen offset:128
    buffer_load_dwordx4 v[40:43], v25, s[20:23], s48 offen offset:192
    s_branch L_block
L_helper:
    s_setprio 3
    v_lshlrev_b32 v1, 4, v14
    v_lshl_add_u32 v0, v13, 8, v1
    v_mov_b32 v28, 0
    v_mov_b32 v29, 0
    v_mov_b32 v30, 0
    v_mov_b32 v31, 0
    v_mov_b32 v32, 0
    v_mov_b32 v33, 0
    v_mov_b32 v34, 0
    v_mov_b32 v35, 0
    v_mov_b32 v36, 0
    v_mov_b32 v37, 0
    v_mov_b32 v38, 0
    v_mov_b32 v39, 0
    v_mov_b32 v40, 0
    v_mov_b32 v41, 0
    v_mov_b32 v42, 0
    v_mov_b32 v43, 0
    s_mov_b32 exec_lo, 0x00030003
    s_mov_b32 exec_hi, 0x00030003
    buffer_load_dwordx4 v[28:31], v0, s[20:23], s45 offen offset:0
    buffer_load_dwordx4 v[32:35], v0, s[20:23], s45 offen offset:64
    buffer_load_dwordx4 v[36:39], v0, s[20:23], s45 offen offset:128
    buffer_load_dwordx4 v[40:43], v0, s[20:23], s45 offen offset:192
    s_mov_b64 exec, -1
    v_xor_b32 v2, v13, v14
    v_lshlrev_b32 v2, 4, v2
    v_lshl_add_u32 v2, v13, 8, v2
    v_lshrrev_b32 v18, 2, v13
    v_and_b32 v19, 3, v13
    v_mul_u32_u24 v164, 320, v18
    v_lshl_add_u32 v164, v19, 3, v164
    v_mul_u32_u24 v27, 1056, v14
    v_xor_b32 v3, 64, v2
    v_xor_b32 v165, 64, v164
    v_xor_b32 v4, 128, v2
    v_xor_b32 v166, 128, v164
    v_xor_b32 v5, 192, v2
    v_xor_b32 v167, 192, v164
    v_add_u32 v6, v27, v164
    v_add_u32 v7, v27, v165
    v_add_u32 v8, v27, v166
    v_add_u32 v9, v27, v167
    v_mov_b32 v20, 0x3f803f80
    v_mov_b32 v21, 0x3f803f80
    v_mov_b32 v22, 0x3f803f80
    v_mov_b32 v23, 0x3f803f80
    s_mul_i32 s91, s44, 1056
    s_add_u32 s91, s91, 9312
    v_lshl_add_u32 v1, v13, 9, v1
    v_add_u32 v1, s91, v1
    v_lshlrev_b32 v24, 3, v13
    v_add_u32 v24, s91, v24
    v_lshl_add_u32 v25, v14, 4, v13
    v_lshrrev_b32 v17, 5, v25
    v_lshlrev_b32 v17, 3, v17
    v_lshlrev_b32 v10, 4, v25
    v_and_b32 v11, 7, v25
    v_lshlrev_b32 v18, 3, v17
    v_lshl_add_u32 v12, v11, 3, v18
    v_lshl_add_u32 v11, v11, 11, v18
    v_lshlrev_b32 v25, 3, v25
    v_mov_b32 v56, 0
    v_mov_b32 v57, 0
    v_mov_b32 v58, 0
    v_mov_b32 v59, 0
    v_mov_b32 v60, 0
    v_mov_b32 v61, 0
    v_mov_b32 v62, 0
    v_mov_b32 v63, 0
    v_mov_b32 v64, 0
    v_mov_b32 v65, 0
    v_mov_b32 v66, 0
    v_mov_b32 v67, 0
    v_mov_b32 v68, 0
    v_mov_b32 v69, 0
    v_mov_b32 v70, 0
    v_mov_b32 v71, 0
    v_mov_b32 v72, 0
    v_mov_b32 v73, 0
    v_mov_b32 v74, 0
    v_mov_b32 v75, 0
    v_mov_b32 v76, 0
    v_mov_b32 v77, 0
    v_mov_b32 v78, 0
    v_mov_b32 v79, 0
    v_mov_b32 v80, 0
    v_mov_b32 v81, 0
    v_mov_b32 v82, 0
    v_mov_b32 v83, 0
    v_mov_b32 v84, 0
    v_mov_b32 v85, 0
    v_mov_b32 v86, 0
    v_mov_b32 v87, 0
    v_mov_b32 v88, 0
    v_mov_b32 v89, 0
    v_mov_b32 v90, 0
    v_mov_b32 v91, 0
    v_mov_b32 v156, s51
    s_sub_u32 s85, s44, 1
    s_lshl_b32 s47, s85, 1
    s_add_u32 s82, s47, 2
    s_sub_u32 s48, 14, s47
    s_cmp_eq_u32 s55, 0
    s_cselect_b32 s47, s47, s48
    s_cselect_b32 s90, 1, -1
    s_mul_i32 s88, s90, 16384
    s_mul_i32 s90, s90, 16896
    s_lshl_b32 s48, s47, 12
    s_add_u32 s48, s48, 13824
    s_mul_i32 s49, s47, 4224
    s_add_u32 s49, s49, 87808
    v_add_u32 v2, s48, v2
    v_add_u32 v6, s49, v6
    v_add_u32 v3, s48, v3
    v_add_u32 v7, s49, v7
    v_add_u32 v4, s48, v4
    v_add_u32 v8, s49, v8
    v_add_u32 v5, s48, v5
    v_add_u32 v9, s49, v9
    s_lshl_b32 s87, s53, 3
    s_add_u32 s87, s87, s54
    s_lshl_b32 s87, s87, 11
    s_mov_b32 s83, 1
    s_waitcnt vmcnt(0)
L_hloop:
    s_cmp_gt_u32 s82, 12
    s_addc_u32 s49, s82, 0
L_poll18:
    ds_read_b32 v27, v16
    s_waitcnt lgkmcnt(0)
    v_readfirstlane_b32 s47, v27
    s_nop 0
    s_cmp_ge_i32 s47, s49
    s_cbranch_scc1 L_pdone18
    s_sleep 1
    s_branch L_poll18
L_pdone18:
    s_lshr_b32 s48, s82, 1
    s_add_u32 s48, s48, 15
    s_add_u32 s95, s82, 1
    s_min_u32 s95, s95, 16
    s_cmp_gt_u32 s95, 11
    s_addc_u32 s95, s95, 1
    ds_read_b128 v[92:95], v2 offset:0
    ds_read_b128 v[96:99], v3 offset:0
    ds_read_b128 v[100:103], v4 offset:0
    ds_read_b128 v[104:107], v5 offset:0
    ds_read_b128 v[108:111], v2 offset:4096
    ds_read_b128 v[112:115], v3 offset:4096
    ds_read_b128 v[116:119], v4 offset:4096
    ds_read_b128 v[120:123], v5 offset:4096
    s_waitcnt lgkmcnt(7)
    v_mfma_f32_16x16x32_bf16 v[44:47], v[92:95], v[28:31], 0
    s_waitcnt lgkmcnt(6)
    v_mfma_f32_16x16x32_bf16 v[44:47], v[96:99], v[32:35], v[44:47]
    s_waitcnt lgkmcnt(5)
    v_mfma_f32_16x16x32_bf16 v[44:47], v[100:103], v[36:39], v[44:47]
    s_waitcnt lgkmcnt(4)
    v_mfma_f32_16x16x32_bf16 v[44:47], v[104:107], v[40:43], v[44:47]
    s_waitcnt lgkmcnt(3)
    v_mfma_f32_16x16x32_bf16 v[48:51], v[108:111], v[28:31], 0
    s_waitcnt lgkmcnt(2)
    v_mfma_f32_16x16x32_bf16 v[48:51], v[112:115], v[32:35], v[48:51]
    s_waitcnt lgkmcnt(1)
    v_mfma_f32_16x16x32_bf16 v[48:51], v[116:119], v[36:39], v[48:51]
    s_waitcnt lgkmcnt(0)
    v_mfma_f32_16x16x32_bf16 v[48:51], v[120:123], v[40:43], v[48:51]
    s_lshl_b32 s47, 1, s48
    v_mov_b32 v27, s47
    s_mov_b64 exec, 1
    ds_or_b32 v16, v27 offset:4
    s_mov_b64 exec, -1
    v_max3_f32 v18, v44, v45, v46
    s_nop 1
    v_max3_f32 v18, v18, v47, v48
    v_max3_f32 v18, v18, v49, v50
    v_max_f32 v18, v18, v51
    v_mov_b32 v19, v18
    s_nop 1
    v_permlane32_swap_b32 v18, v19
    v_max_f32 v18, v18, v19
    v_mov_b32 v19, v18
    s_nop 1
    v_permlane16_swap_b32 v18, v19
    v_max_f32 v18, v18, v19
    v_mul_f32 v18, s58, v18
    v_max_f32 v18, v18, v156
    v_sub_f32 v19, v156, v18
    v_exp_f32 v19, v19
    v_mov_b32 v156, v18
    v_fma_f32 v44, v44, s58, -v18
    v_fma_f32 v45, v45, s58, -v18
    v_fma_f32 v46, v46, s58, -v18
    v_fma_f32 v47, v47, s58, -v18
    v_fma_f32 v48, v48, s58, -v18
    v_fma_f32 v49, v49, s58, -v18
    v_fma_f32 v50, v50, s58, -v18
    v_fma_f32 v51, v51, s58, -v18
    v_exp_f32 v44, v44
    v_exp_f32 v45, v45
    v_exp_f32 v46, v46
    v_exp_f32 v47, v47
    v_exp_f32 v48, v48
    v_exp_f32 v49, v49
    v_exp_f32 v50, v50
    v_exp_f32 v51, v51
    v_mul_f32 v56, v56, v19
    v_mul_f32 v57, v57, v19
    v_mul_f32 v58, v58, v19
    v_mul_f32 v59, v59, v19
    v_mul_f32 v60, v60, v19
    v_mul_f32 v61, v61, v19
    v_mul_f32 v62, v62, v19
    v_mul_f32 v63, v63, v19
    v_mul_f32 v64, v64, v19
    v_mul_f32 v65, v65, v19
    v_mul_f32 v66, v66, v19
    v_mul_f32 v67, v67, v19
    v_mul_f32 v68, v68, v19
    v_mul_f32 v69, v69, v19
    v_mul_f32 v70, v70, v19
    v_mul_f32 v71, v71, v19
    v_mul_f32 v72, v72, v19
    v_mul_f32 v73, v73, v19
    v_mul_f32 v74, v74, v19
    v_mul_f32 v75, v75, v19
    v_mul_f32 v76, v76, v19
    v_mul_f32 v77, v77, v19
    v_mul_f32 v78, v78, v19
    v_mul_f32 v79, v79, v19
    v_mul_f32 v80, v80, v19
    v_mul_f32 v81, v81, v19
    v_mul_f32 v82, v82, v19
    v_mul_f32 v83, v83, v19
    v_mul_f32 v84, v84, v19
    v_mul_f32 v85, v85, v19
    v_mul_f32 v86, v86, v19
    v_mul_f32 v87, v87, v19
    v_mul_f32 v88, v88, v19
    v_cvt_pk_bf16_f32 v44, v44, v45
    v_cvt_pk_bf16_f32 v45, v46, v47
    v_cvt_pk_bf16_f32 v46, v48, v49
    v_cvt_pk_bf16_f32 v47, v50, v51
    s_nop 1
    v_mfma_f32_16x16x32_bf16 v[88:91], v[20:23], v[44:47], v[88:91]
    s_nop 7
L_poll19:
    ds_read_b32 v27, v16
    s_waitcnt lgkmcnt(0)
    v_readfirstlane_b32 s47, v27
    s_nop 0
    s_cmp_ge_i32 s47, s95
    s_cbranch_scc1 L_pdone19
    s_sleep 1
    s_branch L_poll19
L_pdone19:
    ds_read_b64_tr_b16 v[124:125], v6 offset:0
    ds_read_b64_tr_b16 v[126:127], v6 offset:4224
    ds_read_b64_tr_b16 v[128:129], v6 offset:32
    ds_read_b64_tr_b16 v[130:131], v6 offset:4256
    ds_read_b64_tr_b16 v[132:133], v7 offset:0
    ds_read_b64_tr_b16 v[134:135], v7 offset:4224
    ds_read_b64_tr_b16 v[136:137], v7 offset:32
    ds_read_b64_tr_b16 v[138:139], v7 offset:4256
    ds_read_b64_tr_b16 v[140:141], v8 offset:0
    ds_read_b64_tr_b16 v[142:143], v8 offset:4224
    ds_read_b64_tr_b16 v[144:145], v8 offset:32
    ds_read_b64_tr_b16 v[146:147], v8 offset:4256
    ds_read_b64_tr_b16 v[148:149], v9 offset:0
    ds_read_b64_tr_b16 v[150:151], v9 offset:4224
    ds_read_b64_tr_b16 v[152:153], v9 offset:32
    ds_read_b64_tr_b16 v[154:155], v9 offset:4256
    v_add_u32 v2, s88, v2
    v_add_u32 v6, s90, v6
    v_add_u32 v3, s88, v3
    v_add_u32 v7, s90, v7
    v_add_u32 v4, s88, v4
    v_add_u32 v8, s90, v8
    v_add_u32 v5, s88, v5
    v_add_u32 v9, s90, v9
    s_waitcnt lgkmcnt(14)
    v_mfma_f32_16x16x32_bf16 v[56:59], v[124:127], v[44:47], v[56:59]
    s_waitcnt lgkmcnt(12)
    v_mfma_f32_16x16x32_bf16 v[60:63], v[128:131], v[44:47], v[60:63]
    s_waitcnt lgkmcnt(10)
    v_mfma_f32_16x16x32_bf16 v[64:67], v[132:135], v[44:47], v[64:67]
    s_waitcnt lgkmcnt(8)
    v_mfma_f32_16x16x32_bf16 v[68:71], v[136:139], v[44:47], v[68:71]
    s_waitcnt lgkmcnt(6)
    v_mfma_f32_16x16x32_bf16 v[72:75], v[140:143], v[44:47], v[72:75]
    s_waitcnt lgkmcnt(4)
    v_mfma_f32_16x16x32_bf16 v[76:79], v[144:147], v[44:47], v[76:79]
    s_waitcnt lgkmcnt(2)
    v_mfma_f32_16x16x32_bf16 v[80:83], v[148:151], v[44:47], v[80:83]
    s_waitcnt lgkmcnt(0)
    v_mfma_f32_16x16x32_bf16 v[84:87], v[152:155], v[44:47], v[84:87]
    s_add_u32 s82, s82, 4
    s_cmp_le_u32 s82, 16
    s_nop 5
    s_cbranch_scc1 L_hloop
    v_mov_b32 v157, v88
    s_mov_b32 exec_lo, 0x00030003
    s_mov_b32 exec_hi, 0x00030003
    ds_write_b128 v1, v[56:59] offset:0
    ds_write_b128 v1, v[60:63] offset:64
    ds_write_b128 v1, v[64:67] offset:128
    ds_write_b128 v1, v[68:71] offset:192
    ds_write_b128 v1, v[72:75] offset:256
    ds_write_b128 v1, v[76:79] offset:320
    ds_write_b128 v1, v[80:83] offset:384
    ds_write_b128 v1, v[84:87] offset:448
    s_mov_b64 exec, 3
    ds_write_b64 v24, v[156:157] offset:1024
    s_mov_b64 exec, -1
    s_cmp_lg_u32 s85, 0
    s_cbranch_scc1 L_hmerge
    s_waitcnt lgkmcnt(0)
    s_lshl_b32 s47, 1, 24
    v_mov_b32 v27, s47
    s_mov_b64 exec, 1
    ds_or_b32 v16, v27 offset:4
    s_mov_b64 exec, -1
    s_branch L_hdone
L_hmerge:
    s_mov_b32 s49, 16777216
L_poll20:
    ds_read_b32 v27, v16 offset:4
    s_waitcnt lgkmcnt(0)
    v_readfirstlane_b32 s47, v27
    s_nop 0
    s_andn2_b32 s47, s49, s47
    s_cbranch_scc0 L_pdone20
    s_sleep 1
    s_branch L_poll20
L_pdone20:
    ds_read_b64 v[64:65], v17 offset:11392
    ds_read_b64 v[66:67], v17 offset:12448
    ds_read_b128 v[56:59], v10 offset:10368
    ds_read_b128 v[60:63], v10 offset:11424
    s_lshl_b32 s47, s53, 2
    v_mov_b32 v0, s83
    s_waitcnt lgkmcnt(2)
    v_max_f32 v156, v64, v66
    v_sub_f32 v64, v64, v156
    v_sub_f32 v66, v66, v156
    v_exp_f32 v64, v64
    v_exp_f32 v66, v66
    s_waitcnt lgkmcnt(1)
    v_mul_f32 v56, v56, v64
    v_mul_f32 v57, v57, v64
    v_mul_f32 v58, v58, v64
    v_mul_f32 v59, v59, v64
    v_mul_f32 v157, v65, v64
    s_waitcnt lgkmcnt(0)
    v_fmac_f32 v56, v60, v66
    v_fmac_f32 v57, v61, v66
    v_fmac_f32 v58, v62, v66
    v_fmac_f32 v59, v63, v66
    v_fmac_f32 v157, v67, v66
    buffer_store_dwordx4 v[56:59], v10, s[40:43], s87 offen sc1
    s_mov_b32 exec_lo, 0xff
    s_mov_b32 exec_hi, 0xff
    buffer_store_dwordx2 v[156:157], v12, s[40:43], s87 offen offset:1024 sc1
    s_mov_b64 exec, 1
    v_mov_b32 v27, 33554432
    ds_or_b32 v16, v27 offset:4
    s_waitcnt vmcnt(0)
    buffer_atomic_add v0, off, s[36:39], s47 sc0
    s_waitcnt vmcnt(0)
    v_readfirstlane_b32 s48, v0
    s_mov_b64 exec, -1
    s_and_b32 s49, s48, 31
    s_cmp_eq_u32 s49, 7
    s_nop 1
    s_cbranch_scc0 L_hdone
    s_lshl_b32 s87, s53, 14
    buffer_load_dwordx2 v[156:157], v11, s[40:43], s87 offen offset:1024 sc1
    buffer_load_dwordx4 v[56:59], v10, s[40:43], s87 offen offset:0 sc1
    buffer_load_dwordx4 v[60:63], v10, s[40:43], s87 offen offset:2048 sc1
    s_add_u32 s87, s87, 4096
    buffer_load_dwordx4 v[64:67], v10, s[40:43], s87 offen offset:0 sc1
    buffer_load_dwordx4 v[68:71], v10, s[40:43], s87 offen offset:2048 sc1
    s_add_u32 s87, s87, 4096
    buffer_load_dwordx4 v[72:75], v10, s[40:43], s87 offen offset:0 sc1
    buffer_load_dwordx4 v[76:79], v10, s[40:43], s87 offen offset:2048 sc1
    s_add_u32 s87, s87, 4096
    buffer_load_dwordx4 v[80:83], v10, s[40:43], s87 offen offset:0 sc1
    buffer_load_dwordx4 v[84:87], v10, s[40:43], s87 offen offset:2048 sc1
L_got:
    s_waitcnt vmcnt(8)
    v_mov_b32 v18, v156
    ds_swizzle_b32 v19, v18 offset:0x41f
    s_waitcnt lgkmcnt(0)
    v_max_f32 v18, v18, v19
    ds_swizzle_b32 v19, v18 offset:0x81f
    s_waitcnt lgkmcnt(0)
    v_max_f32 v18, v18, v19
    ds_swizzle_b32 v19, v18 offset:0x101f
    s_waitcnt lgkmcnt(0)
    v_max_f32 v18, v18, v19
    v_sub_f32 v156, v156, v18
    v_exp_f32 v156, v156
    s_nop 0
    v_mul_f32 v18, v156, v157
    ds_swizzle_b32 v96, v156 offset:0x18
    ds_swizzle_b32 v97, v156 offset:0x38
    ds_swizzle_b32 v98, v156 offset:0x58
    ds_swizzle_b32 v99, v156 offset:0x78
    ds_swizzle_b32 v100, v156 offset:0x98
    ds_swizzle_b32 v101, v156 offset:0xb8
    ds_swizzle_b32 v102, v156 offset:0xd8
    ds_swizzle_b32 v103, v156 offset:0xf8
    ds_swizzle_b32 v19, v18 offset:0x41f
    s_waitcnt lgkmcnt(0)
    v_add_f32 v18, v18, v19
    ds_swizzle_b32 v19, v18 offset:0x81f
    s_waitcnt lgkmcnt(0)
    v_add_f32 v18, v18, v19
    ds_swizzle_b32 v19, v18 offset:0x101f
    s_waitcnt lgkmcnt(0)
    v_add_f32 v18, v18, v19
    v_rcp_f32 v18, v18
    s_waitcnt vmcnt(7)
    v_mul_f32 v2, v96, v56
    v_mul_f32 v3, v96, v57
    v_mul_f32 v4, v96, v58
    v_mul_f32 v5, v96, v59
    s_waitcnt vmcnt(6)
    v_fmac_f32 v2, v97, v60
    v_fmac_f32 v3, v97, v61
    v_fmac_f32 v4, v97, v62
    v_fmac_f32 v5, v97, v63
    s_waitcnt vmcnt(5)
    v_fmac_f32 v2, v98, v64
    v_fmac_f32 v3, v98, v65
    v_fmac_f32 v4, v98, v66
    v_fmac_f32 v5, v98, v67
    s_waitcnt vmcnt(4)
    v_fmac_f32 v2, v99, v68
    v_fmac_f32 v3, v99, v69
    v_fmac_f32 v4, v99, v70
    v_fmac_f32 v5, v99, v71
    s_waitcnt vmcnt(3)
    v_fmac_f32 v2, v100, v72
    v_fmac_f32 v3, v100, v73
    v_fmac_f32 v4, v100, v74
    v_fmac_f32 v5, v100, v75
    s_waitcnt vmcnt(2)
    v_fmac_f32 v2, v101, v76
    v_fmac_f32 v3, v101, v77
    v_fmac_f32 v4, v101, v78
    v_fmac_f32 v5, v101, v79
    s_waitcnt vmcnt(1)
    v_fmac_f32 v2, v102, v80
    v_fmac_f32 v3, v102, v81
    v_fmac_f32 v4, v102, v82
    v_fmac_f32 v5, v102, v83
    s_waitcnt vmcnt(0)
    v_fmac_f32 v2, v103, v84
    v_fmac_f32 v3, v103, v85
    v_fmac_f32 v4, v103, v86
    v_fmac_f32 v5, v103, v87
    v_mul_f32 v2, v2, v18
    v_mul_f32 v3, v3, v18
    v_mul_f32 v4, v4, v18
    v_mul_f32 v5, v5, v18
    v_cvt_pk_bf16_f32 v6, v2, v3
    v_cvt_pk_bf16_f32 v7, v4, v5
    buffer_store_dwordx2 v[6:7], v25, s[32:35], s45 offen sc1
    s_nop 1
L_hdone:
L_end:
    s_endpgm
L_wait12:
    s_sleep 1
    ds_read_b32 v27, v16
    s_waitcnt lgkmcnt(0)
    v_readfirstlane_b32 s47, v27
    s_nop 0
    s_cmp_ge_i32 s47, s82
    s_cbranch_scc0 L_wait12
    s_branch L_back12
L_halo:
    s_waitcnt vmcnt(4)
    s_add_u32 s47, s80, -2
    s_cmp_lt_u32 s47, 16
    s_cbranch_scc0 L_rl0
    ds_read_b128 v[84:87], v2 offset:0
    ds_read_b128 v[88:91], v3 offset:0
    ds_read_b128 v[92:95], v4 offset:0
    ds_read_b128 v[96:99], v5 offset:0
    s_branch L_rd0
L_rl0:
    ds_write_b128 v24, v[84:87]
    ds_read_b128 v[84:87], v17
    ds_write_b128 v24, v[88:91]
    ds_read_b128 v[88:91], v17
    ds_write_b128 v24, v[92:95]
    ds_read_b128 v[92:95], v17
    ds_write_b128 v24, v[96:99]
    ds_read_b128 v[96:99], v17
L_rd0:
    s_add_u32 s47, s80, -1
    s_cmp_lt_u32 s47, 16
    s_cbranch_scc0 L_rl1
    ds_read_b128 v[100:103], v2 offset:4096
    ds_read_b128 v[104:107], v3 offset:4096
    ds_read_b128 v[108:111], v4 offset:4096
    ds_read_b128 v[112:115], v5 offset:4096
    s_branch L_rd1
L_rl1:
    ds_write_b128 v24, v[100:103]
    ds_read_b128 v[100:103], v17
    ds_write_b128 v24, v[104:107]
    ds_read_b128 v[104:107], v17
    ds_write_b128 v24, v[108:111]
    ds_read_b128 v[108:111], v17
    ds_write_b128 v24, v[112:115]
    ds_read_b128 v[112:115], v17
L_rd1:
    s_add_u32 s47, s80, 1
    s_cmp_lt_u32 s47, 16
    s_cbranch_scc0 L_rl3
    ds_read_b128 v[132:135], v2 offset:12288
    ds_read_b128 v[136:139], v3 offset:12288
    ds_read_b128 v[140:143], v4 offset:12288
    ds_read_b128 v[144:147], v5 offset:12288
    s_branch L_rd3
L_rl3:
    ds_write_b128 v24, v[132:135]
    ds_read_b128 v[132:135], v17
    ds_write_b128 v24, v[136:139]
    ds_read_b128 v[136:139], v17
    ds_write_b128 v24, v[140:143]
    ds_read_b128 v[140:143], v17
    ds_write_b128 v24, v[144:147]
    ds_read_b128 v[144:147], v17
L_rd3:
    s_add_u32 s47, s80, 2
    s_cmp_lt_u32 s47, 16
    s_cbranch_scc0 L_rl4
    ds_read_b128 v[148:151], v2 offset:16384
    ds_read_b128 v[152:155], v3 offset:16384
    ds_read_b128 v[156:159], v4 offset:16384
    ds_read_b128 v[160:163], v5 offset:16384
    s_branch L_rd4
L_rl4:
    ds_write_b128 v24, v[148:151]
    ds_read_b128 v[148:151], v17
    ds_write_b128 v24, v[152:155]
    ds_read_b128 v[152:155], v17
    ds_write_b128 v24, v[156:159]
    ds_read_b128 v[156:159], v17
    ds_write_b128 v24, v[160:163]
    ds_read_b128 v[160:163], v17
L_rd4:
    s_branch L_kdone
L_wait13:
    s_sleep 1
    ds_read_b32 v26, v16
    s_waitcnt lgkmcnt(0)
    v_readfirstlane_b32 s47, v26
    s_nop 0
    s_cmp_ge_i32 s47, s95
    s_cbranch_scc0 L_wait13
    s_branch L_back13
L_wait14:
    s_sleep 1
    ds_read_b32 v26, v16
    s_waitcnt lgkmcnt(0)
    v_readfirstlane_b32 s47, v26
    s_nop 0
    s_cmp_ge_i32 s47, s95
    s_cbranch_scc0 L_wait14
    s_branch L_back14
L_edge:
    v_mfma_f32_16x16x32_bf16 v[44:47], v[84:87], v[28:31], v[44:47]
    v_mfma_f32_16x16x32_bf16 v[44:47], v[88:91], v[32:35], v[44:47]
    v_mfma_f32_16x16x32_bf16 v[44:47], v[92:95], v[36:39], v[44:47]
    v_mfma_f32_16x16x32_bf16 v[44:47], v[96:99], v[40:43], v[44:47]
    v_mfma_f32_16x16x32_bf16 v[48:51], v[100:103], v[28:31], 0
    v_mfma_f32_16x16x32_bf16 v[48:51], v[104:107], v[32:35], v[48:51]
    v_mfma_f32_16x16x32_bf16 v[48:51], v[108:111], v[36:39], v[48:51]
    v_mfma_f32_16x16x32_bf16 v[48:51], v[112:115], v[40:43], v[48:51]
    v_mfma_f32_16x16x32_bf16 v[52:55], v[116:119], v[28:31], 0
    v_mfma_f32_16x16x32_bf16 v[52:55], v[120:123], v[32:35], v[52:55]
    v_mfma_f32_16x16x32_bf16 v[52:55], v[124:127], v[36:39], v[52:55]
    v_mfma_f32_16x16x32_bf16 v[52:55], v[128:131], v[40:43], v[52:55]
    v_mfma_f32_16x16x32_bf16 v[56:59], v[132:135], v[28:31], 0
    v_mfma_f32_16x16x32_bf16 v[56:59], v[136:139], v[32:35], v[56:59]
    v_mfma_f32_16x16x32_bf16 v[56:59], v[140:143], v[36:39], v[56:59]
    v_mfma_f32_16x16x32_bf16 v[56:59], v[144:147], v[40:43], v[56:59]
    v_mfma_f32_16x16x32_bf16 v[60:63], v[148:151], v[28:31], v[60:63]
    v_mfma_f32_16x16x32_bf16 v[60:63], v[152:155], v[32:35], v[60:63]
    v_mfma_f32_16x16x32_bf16 v[60:63], v[156:159], v[36:39], v[60:63]
    v_mfma_f32_16x16x32_bf16 v[60:63], v[160:163], v[40:43], v[60:63]
    v_add_u32 v19, s52, v15
    s_movk_i32 s48, 2046
    v_add_u32 v0, 0, v19
    v_cmp_gt_u32 vcc, s48, v0
    s_nop 1
    v_cndmask_b32 v44, v18, v44, vcc
    v_add_u32 v0, 1, v19
    v_cmp_gt_u32 vcc, s48, v0
    s_nop 1
    v_cndmask_b32 v45, v18, v45, vcc
    v_add_u32 v0, 2, v19
    v_cmp_gt_u32 vcc, s48, v0
    s_nop 1
    v_cndmask_b32 v46, v18, v46, vcc
    v_add_u32 v0, 3, v19
    v_cmp_gt_u32 vcc, s48, v0
    s_nop 1
    v_cndmask_b32 v47, v18, v47, vcc
    v_add_u32 v0, 16, v19
    v_cmp_gt_u32 vcc, s48, v0
    s_nop 1
    v_cndmask_b32 v48, v18, v48, vcc
    v_add_u32 v0, 17, v19
    v_cmp_gt_u32 vcc, s48, v0
    s_nop 1
    v_cndmask_b32 v49, v18, v49, vcc
    v_add_u32 v0, 18, v19
    v_cmp_gt_u32 vcc, s48, v0
    s_nop 1
    v_cndmask_b32 v50, v18, v50, vcc
    v_add_u32 v0, 19, v19
    v_cmp_gt_u32 vcc, s48, v0
    s_nop 1
    v_cndmask_b32 v51, v18, v51, vcc
    v_add_u32 v0, 32, v19
    v_cmp_gt_u32 vcc, s48, v0
    s_nop 1
    v_cndmask_b32 v52, v18, v52, vcc
    v_add_u32 v0, 33, v19
    v_cmp_gt_u32 vcc, s48, v0
    s_nop 1
    v_cndmask_b32 v53, v18, v53, vcc
    v_add_u32 v0, 34, v19
    v_cmp_gt_u32 vcc, s48, v0
    s_nop 1
    v_cndmask_b32 v54, v18, v54, vcc
    v_add_u32 v0, 35, v19
    v_cmp_gt_u32 vcc, s48, v0
    s_nop 1
    v_cndmask_b32 v55, v18, v55, vcc
    v_add_u32 v0, 48, v19
    v_cmp_gt_u32 vcc, s48, v0
    s_nop 1
    v_cndmask_b32 v56, v18, v56, vcc
    v_add_u32 v0, 49, v19
    v_cmp_gt_u32 vcc, s48, v0
    s_nop 1
    v_cndmask_b32 v57, v18, v57, vcc
    v_add_u32 v0, 50, v19
    v_cmp_gt_u32 vcc, s48, v0
    s_nop 1
    v_cndmask_b32 v58, v18, v58, vcc
    v_add_u32 v0, 51, v19
    v_cmp_gt_u32 vcc, s48, v0
    s_nop 1
    v_cndmask_b32 v59, v18, v59, vcc
    v_add_u32 v0, 64, v19
    v_cmp_gt_u32 vcc, s48, v0
    s_nop 1
    v_cndmask_b32 v60, v18, v60, vcc
    v_add_u32 v0, 65, v19
    v_cmp_gt_u32 vcc, s48, v0
    s_nop 1
    v_cndmask_b32 v61, v18, v61, vcc
    v_add_u32 v0, 66, v19
    v_cmp_gt_u32 vcc, s48, v0
    s_nop 1
    v_cndmask_b32 v62, v18, v62, vcc
    v_add_u32 v0, 67, v19
    v_cmp_gt_u32 vcc, s48, v0
    s_nop 1
    v_cndmask_b32 v63, v18, v63, vcc
    s_waitcnt lgkmcnt(0)
    v_readfirstlane_b32 s47, v26
    s_nop 0
    s_cmp_ge_i32 s47, s95
    s_cbranch_scc0 L_wait14
L_back14:
    ds_read_b64_tr_b16 v[92:93], v6 offset:0
    ds_read_b64_tr_b16 v[94:95], v6 offset:4224
    ds_read_b64_tr_b16 v[96:97], v6 offset:8448
    ds_read_b64_tr_b16 v[98:99], v6 offset:12672
    ds_read_b64_tr_b16 v[100:101], v6 offset:16896
    ds_read_b64_tr_b16 v[102:103], v164 offset:0
    ds_read_b64_tr_b16 v[104:105], v6 offset:32
    ds_read_b64_tr_b16 v[106:107], v6 offset:4256
    ds_read_b64_tr_b16 v[108:109], v6 offset:8480
    ds_read_b64_tr_b16 v[110:111], v6 offset:12704
    ds_read_b64_tr_b16 v[112:113], v6 offset:16928
    ds_read_b64_tr_b16 v[114:115], v164 offset:32
    ds_read_b64_tr_b16 v[116:117], v7 offset:0
    ds_read_b64_tr_b16 v[118:119], v7 offset:4224
    ds_read_b64_tr_b16 v[120:121], v7 offset:8448
    ds_read_b64_tr_b16 v[122:123], v7 offset:12672
    ds_read_b64_tr_b16 v[124:125], v7 offset:16896
    ds_read_b64_tr_b16 v[126:127], v165 offset:0
    ds_read_b64_tr_b16 v[128:129], v7 offset:32
    ds_read_b64_tr_b16 v[130:131], v7 offset:4256
    ds_read_b64_tr_b16 v[132:133], v7 offset:8480
    ds_read_b64_tr_b16 v[134:135], v7 offset:12704
    ds_read_b64_tr_b16 v[136:137], v7 offset:16928
    ds_read_b64_tr_b16 v[138:139], v165 offset:32
    ds_read_b64_tr_b16 v[140:141], v8 offset:0
    ds_read_b64_tr_b16 v[142:143], v8 offset:4224
    ds_read_b64_tr_b16 v[144:145], v8 offset:8448
    ds_read_b64_tr_b16 v[146:147], v8 offset:12672
    ds_read_b64_tr_b16 v[148:149], v8 offset:16896
    ds_read_b64_tr_b16 v[150:151], v166 offset:0
    ds_read_b64_tr_b16 v[152:153], v8 offset:32
    ds_read_b64_tr_b16 v[154:155], v8 offset:4256
    ds_read_b64_tr_b16 v[156:157], v8 offset:8480
    ds_read_b64_tr_b16 v[158:159], v8 offset:12704
    ds_read_b64_tr_b16 v[160:161], v8 offset:16928
    ds_read_b64_tr_b16 v[162:163], v166 offset:32
    v_max3_f32 v18, v64, v65, v44
    v_max3_f32 v18, v18, v45, v46
    v_max3_f32 v18, v18, v47, v48
    v_max3_f32 v18, v18, v49, v50
    v_max3_f32 v18, v18, v51, v52
    v_max3_f32 v18, v18, v53, v54
    v_max3_f32 v18, v18, v55, v56
    v_max3_f32 v18, v18, v57, v58
    v_max3_f32 v18, v18, v59, v60
    v_max3_f32 v18, v18, v61, v62
    v_max_f32 v18, v18, v63
    s_nop 1
    s_branch L_join
L_first:
    s_lshl_b32 s47, 1, s85
    v_mov_b32 v27, s47
    s_mov_b64 exec, 1
    ds_or_b32 v16, v27 offset:4
    s_mov_b64 exec, -1
    s_cmp_ge_u32 s85, 6
    s_cbranch_scc0 L_second
    s_lshl_b32 s48, s93, 12
    s_add_u32 s48, s48, s46
    buffer_load_dwordx4 v[28:31], v25, s[20:23], s48 offen offset:0
    buffer_load_dwordx4 v[32:35], v25, s[20:23], s48 offen offset:64
    buffer_load_dwordx4 v[36:39], v25, s[20:23], s48 offen offset:128
    buffer_load_dwordx4 v[40:43], v25, s[20:23], s48 offen offset:192
    s_branch L_second
L_codeend:
.section .rodata,"a"
.p2align 6
.amdhsa_kernel standalone__global_local_windowed_global_tokens__prompt_kernel
  .amdhsa_next_free_vgpr 168
  .amdhsa_next_free_sgpr 98
  .amdhsa_accum_offset 168
  .amdhsa_group_segment_fixed_size 0
  .amdhsa_kernarg_size 64
  .amdhsa_user_sgpr_count 2
  .amdhsa_user_sgpr_kernarg_segment_ptr 1
  .amdhsa_system_sgpr_workgroup_id_x 1
.end_amdhsa_kernel
```
